```python
import torch

def _softmax(x, axis=-1):
    return torch.softmax(x, dim=axis)
def _gelu(x):
    return torch.nn.functional.gelu(x, approximate="tanh")
def _silu(x):
    return torch.nn.functional.silu(x)
def _sigmoid(x):
    return torch.sigmoid(x)
def _layernorm(x, axis=-1, eps=1e-5):
    m = x.mean(dim=axis, keepdim=True)
    v = x.var(dim=axis, keepdim=True, unbiased=False)
    return (x - m) / torch.sqrt(v + eps)
def _scatter_add(tgt, idx, src, axis=0):
    return tgt.clone().index_add_(axis, idx, src)
def _segment_sum(src, seg, n):
    out = torch.zeros((n,) + src.shape[1:], dtype=src.dtype)
    return out.index_add_(0, seg, src)
def _pad(x, pw):
    flat = tuple(v for pair in reversed(pw) for v in pair)
    return torch.nn.functional.pad(x, flat)

kernel_name = 'parallel_sum__sliding_local_dilated__dense_activation_silu__prompt'

def setup_inputs():

    _w = (lambda a: (lambda t: t.to(torch.bfloat16) if t.is_floating_point() else t)(torch.as_tensor(a)))
    def _A_setup():
        B, S, D = 1, 2048, 512
        return {
            "x": _w((lambda *s: torch.randn(*s, dtype=torch.bfloat16) * 0.05)(B, S, D)),
            "wqkv": _w((lambda *s: torch.randn(*s, dtype=torch.bfloat16) * 0.05)(D, 3 * D)),
            "wo": _w((lambda *s: torch.randn(*s, dtype=torch.bfloat16) * 0.05)(D, D)),
        }
    _A_in = _A_setup()

    def _B_setup():
        B, S, D, F = 1, 2048, 512, 1792
        return {
            "x": _w((lambda *s: torch.randn(*s, dtype=torch.bfloat16) * 0.05)(B, S, D)),
            "w1": _w((lambda *s: torch.randn(*s, dtype=torch.bfloat16) * 0.8)(D, F) * (D ** -0.5)),
            "w2": _w((lambda *s: torch.randn(*s, dtype=torch.bfloat16) * 0.8)(F, D) * (F ** -0.5)),
        }
    _B_in = _B_setup()

    return {
        "A_x": _A_in["x"],
        "A_wqkv": _A_in["wqkv"],
        "A_wo": _A_in["wo"],
        "B_x": _B_in["x"],
        "B_w1": _B_in["w1"],
        "B_w2": _B_in["w2"],
    }

def reference(A_x, A_wqkv, A_wo, B_x, B_w1, B_w2):
    def _A_ref(x, wqkv, wo):
        B, S, D = x.shape
        H = 32; Dh = D // H
        W, dil = 8, 2
        qkv = (lambda x, *d: x.permute(*d))((x @ wqkv).reshape(B, S, 3, H, Dh), 2, 0, 3, 1, 4)
        q, k, v = qkv[0], qkv[1], qkv[2]
        scale = Dh ** -0.5
        pos = torch.arange(S)
        off = torch.arange(W) * dil
        idx = pos[:, None] - off[None, :]
        mask = idx >= 0
        idx_c = torch.where(mask, idx, 0).reshape(-1)
        kg = k[:, :, idx_c, :].reshape(B, H, S, W, Dh)
        vg = v[:, :, idx_c, :].reshape(B, H, S, W, Dh)
        logits = torch.einsum("bhsd,bhswd->bhsw", q, kg) * scale
        logits = torch.where(mask[None, None, :, :], logits, -1e9)
        attn = _softmax(logits, axis=-1)
        o = torch.einsum("bhsw,bhswd->bhsd", attn, vg)
        return (lambda x, *d: x.permute(*d))(o, 0, 2, 1, 3).reshape(B, S, D) @ wo

    def _B_ref(x, w1, w2):
        h = torch.einsum("bsd,df->bsf", x, w1)
        h = _silu(h)
        out = torch.einsum("bsf,fd->bsd", h, w2)
        return out

    x = A_x
    xn = _layernorm(x, axis=-1)
    return x + _A_ref(xn, A_wqkv, A_wo) + _B_ref(xn, B_w1, B_w2)
```

```asm
; @launch grid=(256,1,1) block=(512,1,1) lds=163840
.amdgcn_target "amdgcn-amd-amdhsa--gfx950"
.text
.globl parallel_sum__sliding_local_dilated__dense_activation_silu__prompt_kernel
.p2align 8
.type parallel_sum__sliding_local_dilated__dense_activation_silu__prompt_kernel,@function
parallel_sum__sliding_local_dilated__dense_activation_silu__prompt_kernel:
    s_cmp_ge_u32 s2, 256
    s_cbranch_scc1 L_done
    s_load_dwordx16 s[36:51], s[0:1], 0
    s_load_dwordx2 s[52:53], s[0:1], 64
    s_getpc_b64 s[4:5]
L_pc:
    s_lshr_b32 s3, s2, 3
    s_lshl_b32 s3, s3, 5
    v_lshrrev_b32 v2, 4, v0
    v_and_b32 v1, 3, v0
    v_add3_u32 v2, v2, v1, s3
    v_and_b32 v2, 0x1ff, v2
    v_lshlrev_b32 v2, 7, v2
    v_min_u32 v2, L_codeend-L_pc-4, v2
    s_mov_b64 exec, 15
    global_load_dword v255, v2, s[4:5]
    s_mov_b64 exec, -1
    v_lshrrev_b32 v2, 6, v0
    v_and_b32 v1, 63, v0
    v_readfirstlane_b32 s54, v2
    s_bfe_u32 s57, s2, 0x10002
    s_lshl_b32 s57, s57, 3
    s_bfe_u32 s3, s2, 0x30003
    s_add_u32 s57, s57, s3
    s_and_b32 s58, s2, 3
    s_lshl_b32 s67, s58, 1
    s_bfe_u32 s86, s2, 0x10006
    s_add_u32 s58, s67, s86
    s_lshr_b32 s59, s2, 7
    s_and_b32 s55, s54, 3
    s_lshl_b32 s66, s55, 12
    s_mul_i32 s72, s55, 7168
    s_and_b32 s68, s2, 4
    s_and_b32 s68, s68, 7
    s_mul_i32 s68, s68, 0x11111111
    s_lshr_b32 s69, s2, 6
    s_add_u32 s69, s69, s3
    s_mov_b32 s61, 0x76543210
    s_mov_b32 s70, 0x76541032
    s_bitcmp1_b32 s69, 0
    s_cselect_b32 s61, 0x76540321, s61
    s_cselect_b32 s70, 0x76542103, s70
    s_bitcmp1_b32 s69, 1
    s_cselect_b32 s61, s70, s61
    s_add_u32 s61, s61, s68
    s_and_b32 s61, s61, 0x77777777
    v_lshrrev_b32 v240, 3, v1
    v_lshrrev_b32 v241, 4, v1
    v_and_b32 v242, 7, v1
    v_xor_b32 v242, v242, v241
    v_lshlrev_b32 v242, 4, v242
    v_lshl_or_b32 v248, v240, 10, v242
    s_lshl_b32 s67, s57, 17
    s_lshl_b32 s68, s55, 15
    s_add_u32 s68, s68, s67
    v_add_u32 v3, s68, v248
    v_add_u32 v4, 0x2000, v3
    v_xor_b32 v4, 64, v4
    s_mul_i32 s68, s58, 448
    s_lshl_b32 s70, s58, 7
    s_movk_i32 s60, 3584
    s_mov_b32 s64, -1
    s_mov_b32 s65, 0x00ffffff
    s_cmp_eq_u32 s59, 0
    s_cselect_b32 s60, 3072, s60
    s_cselect_b32 s68, s70, s68
    s_cselect_b32 s69, 10, 7
    s_cselect_b32 s64, 0xf0ffffff, s64
    s_cselect_b32 s65, 0x000fffff, s65
    s_lshl_b32 s63, s60, 6
    s_lshl_b32 s62, s60, 1
    v_cmp_lt_u32 vcc, 27, v1
    v_subrev_u32 v243, 28, v1
    s_lshl_b32 s67, s55, 4
    s_mul_i32 s67, s67, s60
    s_add_u32 s68, s68, s67
    v_mov_b32 v244, s60
    v_cndmask_b32 v243, v1, v243, vcc
    v_cndmask_b32 v244, 0, v244, vcc
    v_lshrrev_b32 v245, 3, v243
    v_lshlrev_b32 v245, s69, v245
    v_and_b32 v243, 7, v243
    v_lshl_add_u32 v243, v243, 4, v245
    v_add3_u32 v5, v243, v244, s68
    v_lshlrev_b32 v6, 4, v1
    s_lshl_b32 s83, s57, 1
    s_add_u32 s83, s83, s59
    s_lshl_b32 s83, s83, 3
    s_add_u32 s83, s83, s58
    s_lshl_b32 s83, s83, 3
    s_mul_i32 s70, s55, 896
    s_mul_i32 s67, s55, 14
    s_mul_i32 s67, s67, s60
    v_subrev_u32 v246, s67, v5
    s_lshl_b32 s69, s60, 3
    s_lshl_b32 s67, s57, 17
    s_sub_u32 s67, s67, 0x4000
    s_and_b32 s68, s55, 1
    s_lshl_b32 s87, s68, 13
    s_add_u32 s67, s67, s87
    s_lshl_b32 s68, s68, 6
    v_xor_b32 v247, s68, v248
    v_add_u32 v247, s67, v247
    s_and_b32 s87, s55, 2
    s_lshl_b32 s87, s87, 1
    s_lshr_b32 s87, s61, s87
    s_lshl_b32 s79, s55, 10
    s_mov_b32 s10, 0x200000
    s_mov_b32 s11, 0x20000
    s_lshl_b32 s14, s60, 9
    s_mov_b32 s15, 0x20000
    s_cmp_eq_u32 s59, 0
    s_waitcnt lgkmcnt(0)
    s_mov_b32 s8, s36
    s_mov_b32 s9, s37
    s_cselect_b32 s12, s38, s44
    s_cselect_b32 s13, s39, s45
    s_cmp_ge_u32 s54, 4
    s_cbranch_scc1 L_b0
    s_and_b32 s1, s61, 15
    s_lshl_b32 s0, s1, 7
    s_mul_i32 s1, s1, s63
    s_add_u32 m0, s66, 0
    s_nop 0
    buffer_load_dwordx4 v3, s[8:11], s0 offen lds
    s_add_u32 m0, s70, 16384
    s_mov_b64 exec, s[64:65]
    buffer_load_dwordx4 v246, s[12:15], s1 offen lds
    s_mov_b64 exec, -1
    s_add_u32 m0, s66, 1024
    s_nop 0
    buffer_load_dwordx4 v4, s[8:11], s0 offen lds
    s_add_u32 s1, s1, s69
    s_add_u32 m0, s70, 19968
    s_mov_b64 exec, s[64:65]
    buffer_load_dwordx4 v246, s[12:15], s1 offen lds
    s_mov_b64 exec, -1
    s_add_u32 s0, s0, 0x4000
    s_add_u32 m0, s66, 2048
    s_nop 0
    buffer_load_dwordx4 v3, s[8:11], s0 offen lds
    s_add_u32 s1, s1, s69
    s_add_u32 m0, s70, 23552
    s_mov_b64 exec, s[64:65]
    buffer_load_dwordx4 v246, s[12:15], s1 offen lds
    s_mov_b64 exec, -1
    s_add_u32 m0, s66, 3072
    s_nop 0
    buffer_load_dwordx4 v4, s[8:11], s0 offen lds
    s_add_u32 s1, s1, s69
    s_add_u32 m0, s70, 27136
    s_mov_b64 exec, s[64:65]
    buffer_load_dwordx4 v246, s[12:15], s1 offen lds
    s_mov_b64 exec, -1
    s_cmp_eq_u32 s59, 0
    s_cbranch_scc0 L_nh0
    s_bfe_u32 s0, s87, 0x40000
    s_lshl_b32 s0, s0, 7
    s_add_u32 m0, s79, 139264
    s_nop 0
    buffer_load_dwordx4 v247, s[8:11], s0 offen lds
L_nh0:
    s_add_u32 s1, s1, s69
    s_add_u32 m0, s70, 30720
    s_mov_b64 exec, s[64:65]
    buffer_load_dwordx4 v246, s[12:15], s1 offen lds
    s_mov_b64 exec, -1
    s_add_u32 s1, s1, s69
    s_add_u32 m0, s70, 34304
    s_mov_b64 exec, s[64:65]
    buffer_load_dwordx4 v246, s[12:15], s1 offen lds
    s_mov_b64 exec, -1
    s_add_u32 s1, s1, s69
    s_add_u32 m0, s70, 37888
    s_mov_b64 exec, s[64:65]
    buffer_load_dwordx4 v246, s[12:15], s1 offen lds
    s_mov_b64 exec, -1
    s_add_u32 s1, s1, s69
    s_add_u32 m0, s70, 41472
    s_mov_b64 exec, s[64:65]
    buffer_load_dwordx4 v246, s[12:15], s1 offen lds
    s_mov_b64 exec, -1
L_b0:
    s_mov_b32 s32, s50
    s_mov_b32 s33, s51
    s_mov_b32 s34, 0x100
    s_mov_b32 s35, 0x20000
    s_cmp_eq_u32 s2, 0
    s_cselect_b32 s3, s54, 0
    s_cmp_eq_u32 s3, 4
    s_cbranch_scc0 L_nonz
    s_memrealtime s[4:5]
    s_waitcnt lgkmcnt(0)
    s_bitset1_b32 s5, 31
    v_mov_b32 v242, s4
    v_mov_b32 v243, s5
    v_mov_b32 v244, 0
    s_mov_b64 exec, 1
    buffer_store_dwordx2 v[242:243], v244, s[32:35], 0 offen sc1
    s_mov_b64 exec, -1
L_nonz:
    s_mov_b32 s16, s52
    s_mov_b32 s17, s53
    s_mov_b32 s18, 0x1000000
    s_mov_b32 s19, 0x20000
    s_mov_b32 s20, s46
    s_mov_b32 s21, s47
    s_mov_b32 s22, 0x1c0000
    s_mov_b32 s23, 0x20000
    s_mov_b32 s24, s40
    s_mov_b32 s25, s41
    s_mov_b32 s26, 0x80000
    s_mov_b32 s27, 0x20000
    s_mov_b32 s28, s48
    s_mov_b32 s29, s49
    s_mov_b32 s30, 0x200000
    s_mov_b32 s31, 0x20000
    v_bfe_u32 v249, v1, 2, 2
    v_lshrrev_b32 v250, 5, v1
    v_and_b32 v7, 1, v1
    v_lshlrev_b32 v7, 5, v7
    v_and_b32 v242, 16, v1
    v_or_b32 v7, v7, v242
    v_and_b32 v242, 2, v1
    v_lshl_or_b32 v7, v242, 2, v7
    v_lshl_add_u32 v251, v250, 3, v249
    v_mul_u32_u24 v253, 448, v251
    v_add_u32 v253, v253, v7
    v_add_u32 v253, 16384, v253
    s_lshr_b32 s73, s55, 1
    s_and_b32 s74, s55, 1
    s_lshl_b32 s67, s57, 1
    s_add_u32 s67, s67, s73
    s_mul_i32 s71, s67, 294912
    s_lshr_b32 s68, s58, 1
    s_mul_i32 s69, s68, 73728
    s_add_u32 s71, s71, s69
    s_lshl_b32 s70, s74, 10
    s_add_u32 s71, s71, s70
    s_lshl_b32 s69, s86, 12
    s_add_u32 s60, s71, s69
    s_lshl_b32 s69, s86, 1
    s_add_u32 s69, s69, s74
    s_lshl_b32 s70, s69, 12
    s_add_u32 s71, s71, s70
    s_xor_b32 s56, s71, 0x400
    s_lshl_b32 s6, s67, 2
    s_add_u32 s6, s6, s68
    s_lshl_b32 s6, s6, 6
    s_add_u32 s6, s6, s69
    s_lshl_b32 s6, s6, 3
    s_add_u32 s6, s6, 0x910000
    s_mul_i32 s67, s55, 12288
    s_cmp_eq_u32 s55, 3
    s_cselect_b32 s67, 139264, s67
    v_add_u32 v254, s67, v6
    s_cmp_ge_u32 s54, 4
    s_cbranch_scc1 L_B
    v_bfe_u32 v252, v1, 1, 3
    v_xor_b32 v252, v252, v250
    v_and_b32 v242, 31, v1
    v_lshl_add_u32 v244, v242, 7, s66
    v_and_b32 v243, 15, v1
    v_lshlrev_b32 v243, 7, v243
    v_add_u32 v243, 0x22000, v243
    v_xor_b32 v245, 0, v252
    v_lshl_add_u32 v8, v245, 4, v244
    v_xor_b32 v12, 0x1000, v8
    v_lshl_add_u32 v20, v245, 4, v243
    v_xor_b32 v245, 2, v252
    v_lshl_add_u32 v9, v245, 4, v244
    v_xor_b32 v13, 0x1000, v9
    v_lshl_add_u32 v21, v245, 4, v243
    v_xor_b32 v245, 4, v252
    v_lshl_add_u32 v10, v245, 4, v244
    v_xor_b32 v14, 0x1000, v10
    v_lshl_add_u32 v22, v245, 4, v243
    v_xor_b32 v245, 6, v252
    v_lshl_add_u32 v11, v245, 4, v244
    v_xor_b32 v15, 0x1000, v11
    v_lshl_add_u32 v23, v245, 4, v243
    s_lshl_b32 s67, s74, 6
    s_lshl_b32 s68, s73, 7
    v_add_u32 v16, s67, v253
    s_add_u32 s69, s68, 128
    v_add_u32 v17, s69, v16
    s_sub_u32 s70, 256, s68
    v_add_u32 v18, s70, v16
    v_add_u32 v19, 384, v253
    v_add_u32 v27, 155648, v6
    s_lshl_b32 s67, s67, 4
    s_lshl_b32 s69, s69, 4
    s_lshl_b32 s70, s70, 4
    v_add_u32 v24, s67, v27
    v_add_u32 v25, s69, v24
    v_add_u32 v26, s70, v24
    v_add_u32 v27, 6144, v27
    v_mov_b32 v28, v254
    v_mov_b32 v2, 131072
    v_mov_b32 v3, 1
    s_lshl_b32 s67, s55, 3
    s_add_u32 s67, s67, 131072
    v_mov_b32 v5, s67
    s_cmp_eq_u32 s59, 0
    s_cbranch_scc0 L_nh1
    s_bfe_u32 s0, s87, 0x40008
    s_lshl_b32 s0, s0, 7
    s_add_u32 m0, s79, 143360
    s_nop 0
    buffer_load_dwordx4 v247, s[8:11], s0 offen lds
    s_bfe_u32 s0, s87, 0x40010
    s_lshl_b32 s0, s0, 7
    s_add_u32 m0, s79, 147456
    s_nop 0
    buffer_load_dwordx4 v247, s[8:11], s0 offen lds
    s_bfe_u32 s0, s87, 0x40018
    s_lshl_b32 s0, s0, 7
    s_add_u32 m0, s79, 151552
    s_nop 0
    buffer_load_dwordx4 v247, s[8:11], s0 offen lds
L_nh1:
    s_lshl_b32 s67, s55, 1
    s_add_u32 s67, s67, s83
    s_lshl_b32 s67, s67, 10
    buffer_load_dwordx4 v[224:227], v6, s[8:11], s67 offen
    buffer_load_dwordx4 v[236:239], v6, s[8:11], s67 offen offset:1024
    s_cmp_eq_u32 s59, 0
    s_cbranch_scc1 L_A_att
    s_waitcnt vmcnt(6)
    s_barrier
    ds_read_b128 v[64:67], v8
    ds_read_b64_tr_b16 v[72:73], v16 offset:0
    ds_read_b64_tr_b16 v[74:75], v16 offset:1792
    ds_read_b128 v[68:71], v12
    ds_read_b64_tr_b16 v[76:77], v17 offset:0
    ds_read_b64_tr_b16 v[78:79], v17 offset:1792
    ds_read_b64_tr_b16 v[80:81], v18 offset:0
    ds_read_b64_tr_b16 v[82:83], v18 offset:1792
    ds_read_b64_tr_b16 v[84:85], v19 offset:0
    ds_read_b64_tr_b16 v[86:87], v19 offset:1792
    s_waitcnt lgkmcnt(7)
    v_mfma_f32_32x32x16_bf16 v[112:127], v[72:75], v[64:67], 0
    ds_read_b128 v[88:91], v9
    ds_read_b64_tr_b16 v[96:97], v16 offset:7168
    ds_read_b64_tr_b16 v[98:99], v16 offset:8960
    s_waitcnt lgkmcnt(9)
    v_mfma_f32_32x32x16_bf16 v[128:143], v[72:75], v[68:71], 0
    ds_read_b128 v[92:95], v13
    ds_read_b64_tr_b16 v[100:101], v17 offset:7168
    ds_read_b64_tr_b16 v[102:103], v17 offset:8960
    s_waitcnt lgkmcnt(10)
    v_mfma_f32_32x32x16_bf16 v[144:159], v[76:79], v[64:67], 0
    ds_read_b64_tr_b16 v[104:105], v18 offset:7168
    ds_read_b64_tr_b16 v[106:107], v18 offset:8960
    ds_read_b64_tr_b16 v[108:109], v19 offset:7168
    v_mfma_f32_32x32x16_bf16 v[160:175], v[76:79], v[68:71], 0
    ds_read_b64_tr_b16 v[110:111], v19 offset:8960
    v_add_u32 v9, 0xb000, v9
    v_add_u32 v13, 0xb000, v13
    v_add_u32 v8, 0xb000, v8
    v_add_u32 v12, 0xb000, v12
    s_waitcnt lgkmcnt(12)
    v_mfma_f32_32x32x16_bf16 v[176:191], v[80:83], v[64:67], 0
    v_mfma_f32_32x32x16_bf16 v[192:207], v[80:83], v[68:71], 0
    s_waitcnt lgkmcnt(10)
    v_mfma_f32_32x32x16_bf16 v[208:223], v[84:87], v[64:67], 0
    s_waitcnt lgkmcnt(7)
    v_mfma_f32_32x32x16_bf16 v[112:127], v[96:99], v[88:91], v[112:127]
    s_waitcnt vmcnt(2)
    s_barrier
    ds_read_b128 v[64:67], v10
    ds_read_b64_tr_b16 v[72:73], v16 offset:14336
    ds_read_b64_tr_b16 v[74:75], v16 offset:16128
    s_waitcnt lgkmcnt(9)
    v_mfma_f32_32x32x16_bf16 v[128:143], v[96:99], v[92:95], v[128:143]
    ds_read_b128 v[68:71], v14
    ds_read_b64_tr_b16 v[76:77], v17 offset:14336
    ds_read_b64_tr_b16 v[78:79], v17 offset:16128
    s_waitcnt lgkmcnt(10)
    v_mfma_f32_32x32x16_bf16 v[144:159], v[100:103], v[88:91], v[144:159]
    ds_read_b64_tr_b16 v[80:81], v18 offset:14336
    ds_read_b64_tr_b16 v[82:83], v18 offset:16128
    ds_read_b64_tr_b16 v[84:85], v19 offset:14336
    v_mfma_f32_32x32x16_bf16 v[160:175], v[100:103], v[92:95], v[160:175]
    ds_read_b64_tr_b16 v[86:87], v19 offset:16128
    v_add_u32 v10, 0xb000, v10
    v_add_u32 v14, 0xb000, v14
    s_waitcnt lgkmcnt(12)
    v_mfma_f32_32x32x16_bf16 v[176:191], v[104:107], v[88:91], v[176:191]
    v_mfma_f32_32x32x16_bf16 v[192:207], v[104:107], v[92:95], v[192:207]
    s_waitcnt lgkmcnt(10)
    v_mfma_f32_32x32x16_bf16 v[208:223], v[108:111], v[88:91], v[208:223]
    s_waitcnt lgkmcnt(7)
    v_mfma_f32_32x32x16_bf16 v[112:127], v[72:75], v[64:67], v[112:127]
    ds_read_b128 v[88:91], v11
    ds_read_b64_tr_b16 v[96:97], v16 offset:21504
    ds_read_b64_tr_b16 v[98:99], v16 offset:23296
    s_waitcnt lgkmcnt(9)
    v_mfma_f32_32x32x16_bf16 v[128:143], v[72:75], v[68:71], v[128:143]
    ds_read_b128 v[92:95], v15
    ds_read_b64_tr_b16 v[100:101], v17 offset:21504
    ds_read_b64_tr_b16 v[102:103], v17 offset:23296
    s_waitcnt lgkmcnt(10)
    v_mfma_f32_32x32x16_bf16 v[144:159], v[76:79], v[64:67], v[144:159]
    ds_read_b64_tr_b16 v[104:105], v18 offset:21504
    ds_read_b64_tr_b16 v[106:107], v18 offset:23296
    ds_read_b64_tr_b16 v[108:109], v19 offset:21504
    v_mfma_f32_32x32x16_bf16 v[160:175], v[76:79], v[68:71], v[160:175]
    ds_read_b64_tr_b16 v[110:111], v19 offset:23296
    v_add_u32 v11, 0xb000, v11
    v_add_u32 v15, 0xb000, v15
    v_add_u32 v16, 0xb000, v16
    v_add_u32 v17, 0xb000, v17
    s_waitcnt lgkmcnt(12)
    v_mfma_f32_32x32x16_bf16 v[176:191], v[80:83], v[64:67], v[176:191]
    v_add_u32 v18, 0xb000, v18
    v_add_u32 v19, 0xb000, v19
    v_mfma_f32_32x32x16_bf16 v[192:207], v[80:83], v[68:71], v[192:207]
    s_waitcnt lgkmcnt(10)
    v_mfma_f32_32x32x16_bf16 v[208:223], v[84:87], v[64:67], v[208:223]
    s_waitcnt lgkmcnt(0)
    v_mfma_f32_32x32x16_bf16 v[112:127], v[96:99], v[88:91], v[112:127]
    s_barrier
    ds_read_b128 v[64:67], v8
    ds_read_b64_tr_b16 v[72:73], v16 offset:0
    ds_read_b64_tr_b16 v[74:75], v16 offset:1792
    v_mfma_f32_32x32x16_bf16 v[128:143], v[96:99], v[92:95], v[128:143]
    ds_read_b128 v[68:71], v12
    ds_read_b64_tr_b16 v[76:77], v17 offset:0
    ds_read_b64_tr_b16 v[78:79], v17 offset:1792
    v_mfma_f32_32x32x16_bf16 v[144:159], v[100:103], v[88:91], v[144:159]
    ds_read_b64_tr_b16 v[80:81], v18 offset:0
    ds_read_b64_tr_b16 v[82:83], v18 offset:1792
    ds_read_b64_tr_b16 v[84:85], v19 offset:0
    v_mfma_f32_32x32x16_bf16 v[160:175], v[100:103], v[92:95], v[160:175]
    ds_read_b64_tr_b16 v[86:87], v19 offset:1792
    v_add_u32 v8, 0xb000, v8
    v_add_u32 v12, 0xb000, v12
    s_waitcnt vmcnt(0)
    v_lshlrev_b32 v228, 16, v224
    v_mfma_f32_32x32x16_bf16 v[176:191], v[104:107], v[88:91], v[176:191]
    v_lshlrev_b32 v240, 16, v236
    v_and_b32 v229, 0xffff0000, v224
    v_and_b32 v241, 0xffff0000, v236
    v_lshlrev_b32 v230, 16, v225
    v_lshlrev_b32 v242, 16, v237
    v_mfma_f32_32x32x16_bf16 v[192:207], v[104:107], v[92:95], v[192:207]
    v_and_b32 v231, 0xffff0000, v225
    v_and_b32 v243, 0xffff0000, v237
    v_lshlrev_b32 v232, 16, v226
    v_lshlrev_b32 v244, 16, v238
    v_and_b32 v233, 0xffff0000, v226
    v_mfma_f32_32x32x16_bf16 v[208:223], v[108:111], v[88:91], v[208:223]
    v_and_b32 v245, 0xffff0000, v238
    v_lshlrev_b32 v234, 16, v227
    v_lshlrev_b32 v246, 16, v239
    v_and_b32 v235, 0xffff0000, v227
    v_and_b32 v247, 0xffff0000, v239
    v_add_f32 v224, v228, v229
    v_add_f32 v236, v240, v241
    s_waitcnt lgkmcnt(7)
    v_mfma_f32_32x32x16_bf16 v[112:127], v[72:75], v[64:67], v[112:127]
    ds_read_b128 v[88:91], v9
    ds_read_b64_tr_b16 v[96:97], v16 offset:7168
    ds_read_b64_tr_b16 v[98:99], v16 offset:8960
    s_waitcnt lgkmcnt(9)
    v_mfma_f32_32x32x16_bf16 v[128:143], v[72:75], v[68:71], v[128:143]
    ds_read_b128 v[92:95], v13
    ds_read_b64_tr_b16 v[100:101], v17 offset:7168
    ds_read_b64_tr_b16 v[102:103], v17 offset:8960
    s_waitcnt lgkmcnt(10)
    v_mfma_f32_32x32x16_bf16 v[144:159], v[76:79], v[64:67], v[144:159]
    ds_read_b64_tr_b16 v[104:105], v18 offset:7168
    ds_read_b64_tr_b16 v[106:107], v18 offset:8960
    ds_read_b64_tr_b16 v[108:109], v19 offset:7168
    v_mfma_f32_32x32x16_bf16 v[160:175], v[76:79], v[68:71], v[160:175]
    ds_read_b64_tr_b16 v[110:111], v19 offset:8960
    v_add_u32 v9, 0xb000, v9
    v_add_u32 v13, 0xb000, v13
    v_add_f32 v225, v230, v231
    v_add_f32 v237, v242, v243
    s_waitcnt lgkmcnt(12)
    v_mfma_f32_32x32x16_bf16 v[176:191], v[80:83], v[64:67], v[176:191]
    v_add_f32 v226, v232, v233
    v_add_f32 v238, v244, v245
    v_add_f32 v227, v234, v235
    v_add_f32 v239, v246, v247
    v_add_f32 v224, v224, v225
    v_mfma_f32_32x32x16_bf16 v[192:207], v[80:83], v[68:71], v[192:207]
    v_add_f32 v236, v236, v237
    v_add_f32 v226, v226, v227
    v_add_f32 v238, v238, v239
    v_add_f32 v224, v224, v226
    v_add_f32 v236, v236, v238
    s_waitcnt lgkmcnt(10)
    v_mfma_f32_32x32x16_bf16 v[208:223], v[84:87], v[64:67], v[208:223]
    v_add_f32_dpp v224, v224, v224 row_shr:1 row_mask:0xf bank_mask:0xf bound_ctrl:0
    v_add_f32_dpp v236, v236, v236 row_shr:1 row_mask:0xf bank_mask:0xf bound_ctrl:0
    s_nop 0
    v_add_f32_dpp v224, v224, v224 row_shr:2 row_mask:0xf bank_mask:0xf bound_ctrl:0
    v_add_f32_dpp v236, v236, v236 row_shr:2 row_mask:0xf bank_mask:0xf bound_ctrl:0
    s_nop 0
    v_add_f32_dpp v224, v224, v224 row_shr:4 row_mask:0xf bank_mask:0xf bound_ctrl:0
    v_add_f32_dpp v236, v236, v236 row_shr:4 row_mask:0xf bank_mask:0xf bound_ctrl:0
    s_waitcnt lgkmcnt(7)
    v_mfma_f32_32x32x16_bf16 v[112:127], v[96:99], v[88:91], v[112:127]
    ds_read_b128 v[64:67], v10
    ds_read_b64_tr_b16 v[72:73], v16 offset:14336
    ds_read_b64_tr_b16 v[74:75], v16 offset:16128
    s_waitcnt lgkmcnt(9)
    v_mfma_f32_32x32x16_bf16 v[128:143], v[96:99], v[92:95], v[128:143]
    ds_read_b128 v[68:71], v14
    ds_read_b64_tr_b16 v[76:77], v17 offset:14336
    ds_read_b64_tr_b16 v[78:79], v17 offset:16128
    s_waitcnt lgkmcnt(10)
    v_mfma_f32_32x32x16_bf16 v[144:159], v[100:103], v[88:91], v[144:159]
    ds_read_b64_tr_b16 v[80:81], v18 offset:14336
    ds_read_b64_tr_b16 v[82:83], v18 offset:16128
    ds_read_b64_tr_b16 v[84:85], v19 offset:14336
    v_mfma_f32_32x32x16_bf16 v[160:175], v[100:103], v[92:95], v[160:175]
    ds_read_b64_tr_b16 v[86:87], v19 offset:16128
    v_add_u32 v10, 0xb000, v10
    v_add_u32 v14, 0xb000, v14
    v_add_f32_dpp v224, v224, v224 row_shr:8 row_mask:0xf bank_mask:0xf bound_ctrl:0
    v_add_f32_dpp v236, v236, v236 row_shr:8 row_mask:0xf bank_mask:0xf bound_ctrl:0
    s_waitcnt lgkmcnt(12)
    v_mfma_f32_32x32x16_bf16 v[176:191], v[104:107], v[88:91], v[176:191]
    v_add_f32_dpp v224, v224, v224 row_bcast:15 row_mask:0xa bank_mask:0xf
    v_add_f32_dpp v236, v236, v236 row_bcast:15 row_mask:0xa bank_mask:0xf
    s_nop 0
    v_add_f32_dpp v224, v224, v224 row_bcast:31 row_mask:0xc bank_mask:0xf
    v_add_f32_dpp v236, v236, v236 row_bcast:31 row_mask:0xc bank_mask:0xf
    v_readlane_b32 s69, v224, 63
    v_mfma_f32_32x32x16_bf16 v[192:207], v[104:107], v[92:95], v[192:207]
    v_readlane_b32 s70, v236, 63
    v_mov_b32 v225, 0x3b000000
    v_mov_b32 v237, 0x3b000000
    v_mul_f32 v226, s69, v225
    v_mul_f32 v238, s70, v237
    s_waitcnt lgkmcnt(10)
    v_mfma_f32_32x32x16_bf16 v[208:223], v[108:111], v[88:91], v[208:223]
    v_sub_f32 v228, v228, v226
    v_sub_f32 v240, v240, v238
    v_sub_f32 v229, v229, v226
    v_sub_f32 v241, v241, v238
    v_sub_f32 v230, v230, v226
    v_sub_f32 v242, v242, v238
    s_waitcnt lgkmcnt(7)
    v_mfma_f32_32x32x16_bf16 v[112:127], v[72:75], v[64:67], v[112:127]
    ds_read_b128 v[88:91], v11
    ds_read_b64_tr_b16 v[96:97], v16 offset:21504
    ds_read_b64_tr_b16 v[98:99], v16 offset:23296
    s_waitcnt lgkmcnt(9)
    v_mfma_f32_32x32x16_bf16 v[128:143], v[72:75], v[68:71], v[128:143]
    ds_read_b128 v[92:95], v15
    ds_read_b64_tr_b16 v[100:101], v17 offset:21504
    ds_read_b64_tr_b16 v[102:103], v17 offset:23296
    s_waitcnt lgkmcnt(10)
    v_mfma_f32_32x32x16_bf16 v[144:159], v[76:79], v[64:67], v[144:159]
    ds_read_b64_tr_b16 v[104:105], v18 offset:21504
    ds_read_b64_tr_b16 v[106:107], v18 offset:23296
    ds_read_b64_tr_b16 v[108:109], v19 offset:21504
    v_mfma_f32_32x32x16_bf16 v[160:175], v[76:79], v[68:71], v[160:175]
    ds_read_b64_tr_b16 v[110:111], v19 offset:23296
    v_add_u32 v11, 0xb000, v11
    v_add_u32 v15, 0xb000, v15
    v_add_u32 v16, 0xb000, v16
    v_add_u32 v17, 0xb000, v17
    s_waitcnt lgkmcnt(12)
    v_mfma_f32_32x32x16_bf16 v[176:191], v[80:83], v[64:67], v[176:191]
    v_add_u32 v18, 0xb000, v18
    v_add_u32 v19, 0xb000, v19
    v_sub_f32 v231, v231, v226
    v_sub_f32 v243, v243, v238
    v_sub_f32 v232, v232, v226
    v_mfma_f32_32x32x16_bf16 v[192:207], v[80:83], v[68:71], v[192:207]
    v_sub_f32 v244, v244, v238
    v_sub_f32 v233, v233, v226
    v_sub_f32 v245, v245, v238
    v_sub_f32 v234, v234, v226
    v_sub_f32 v246, v246, v238
    s_waitcnt lgkmcnt(10)
    v_mfma_f32_32x32x16_bf16 v[208:223], v[84:87], v[64:67], v[208:223]
    v_sub_f32 v235, v235, v226
    v_sub_f32 v247, v247, v238
    v_mul_f32 v224, v228, v228
    v_mul_f32 v236, v240, v240
    v_mul_f32 v227, v229, v229
    v_mul_f32 v239, v241, v241
    v_fmac_f32 v224, v230, v230
    v_fmac_f32 v236, v242, v242
    v_fmac_f32 v227, v231, v231
    v_fmac_f32 v239, v243, v243
    s_waitcnt lgkmcnt(0)
    v_mfma_f32_32x32x16_bf16 v[112:127], v[96:99], v[88:91], v[112:127]
    s_barrier
    ds_read_b128 v[64:67], v8
    ds_read_b64_tr_b16 v[72:73], v16 offset:0
    ds_read_b64_tr_b16 v[74:75], v16 offset:1792
    v_mfma_f32_32x32x16_bf16 v[128:143], v[96:99], v[92:95], v[128:143]
    ds_read_b128 v[68:71], v12
    ds_read_b64_tr_b16 v[76:77], v17 offset:0
    ds_read_b64_tr_b16 v[78:79], v17 offset:1792
    v_mfma_f32_32x32x16_bf16 v[144:159], v[100:103], v[88:91], v[144:159]
    ds_read_b64_tr_b16 v[80:81], v18 offset:0
    ds_read_b64_tr_b16 v[82:83], v18 offset:1792
    ds_read_b64_tr_b16 v[84:85], v19 offset:0
    v_mfma_f32_32x32x16_bf16 v[160:175], v[100:103], v[92:95], v[160:175]
    ds_read_b64_tr_b16 v[86:87], v19 offset:1792
    v_add_u32 v8, 0xfffea000, v8
    v_add_u32 v12, 0xfffea000, v12
    v_fmac_f32 v224, v232, v232
    v_fmac_f32 v236, v244, v244
    v_mfma_f32_32x32x16_bf16 v[176:191], v[104:107], v[88:91], v[176:191]
    v_fmac_f32 v227, v233, v233
    v_fmac_f32 v239, v245, v245
    v_fmac_f32 v224, v234, v234
    v_fmac_f32 v236, v246, v246
    v_fmac_f32 v227, v235, v235
    v_mfma_f32_32x32x16_bf16 v[192:207], v[104:107], v[92:95], v[192:207]
    v_fmac_f32 v239, v247, v247
    v_add_f32 v224, v224, v227
    v_add_f32 v236, v236, v239
    s_nop 0
    v_add_f32_dpp v224, v224, v224 row_shr:1 row_mask:0xf bank_mask:0xf bound_ctrl:0
    v_add_f32_dpp v236, v236, v236 row_shr:1 row_mask:0xf bank_mask:0xf bound_ctrl:0
    v_mfma_f32_32x32x16_bf16 v[208:223], v[108:111], v[88:91], v[208:223]
    v_add_f32_dpp v224, v224, v224 row_shr:2 row_mask:0xf bank_mask:0xf bound_ctrl:0
    v_add_f32_dpp v236, v236, v236 row_shr:2 row_mask:0xf bank_mask:0xf bound_ctrl:0
    s_nop 0
    v_add_f32_dpp v224, v224, v224 row_shr:4 row_mask:0xf bank_mask:0xf bound_ctrl:0
    v_add_f32_dpp v236, v236, v236 row_shr:4 row_mask:0xf bank_mask:0xf bound_ctrl:0
    s_nop 0
    v_add_f32_dpp v224, v224, v224 row_shr:8 row_mask:0xf bank_mask:0xf bound_ctrl:0
    v_add_f32_dpp v236, v236, v236 row_shr:8 row_mask:0xf bank_mask:0xf bound_ctrl:0
    s_waitcnt lgkmcnt(7)
    v_mfma_f32_32x32x16_bf16 v[112:127], v[72:75], v[64:67], v[112:127]
    ds_read_b128 v[88:91], v9
    ds_read_b64_tr_b16 v[96:97], v16 offset:7168
    ds_read_b64_tr_b16 v[98:99], v16 offset:8960
    s_waitcnt lgkmcnt(9)
    v_mfma_f32_32x32x16_bf16 v[128:143], v[72:75], v[68:71], v[128:143]
    ds_read_b128 v[92:95], v13
    ds_read_b64_tr_b16 v[100:101], v17 offset:7168
    ds_read_b64_tr_b16 v[102:103], v17 offset:8960
    s_waitcnt lgkmcnt(10)
    v_mfma_f32_32x32x16_bf16 v[144:159], v[76:79], v[64:67], v[144:159]
    ds_read_b64_tr_b16 v[104:105], v18 offset:7168
    ds_read_b64_tr_b16 v[106:107], v18 offset:8960
    ds_read_b64_tr_b16 v[108:109], v19 offset:7168
    v_mfma_f32_32x32x16_bf16 v[160:175], v[76:79], v[68:71], v[160:175]
    ds_read_b64_tr_b16 v[110:111], v19 offset:8960
    v_add_u32 v9, 0xfffea000, v9
    v_add_u32 v13, 0xfffea000, v13
    v_add_f32_dpp v224, v224, v224 row_bcast:15 row_mask:0xa bank_mask:0xf
    v_add_f32_dpp v236, v236, v236 row_bcast:15 row_mask:0xa bank_mask:0xf
    s_waitcnt lgkmcnt(12)
    v_mfma_f32_32x32x16_bf16 v[176:191], v[80:83], v[64:67], v[176:191]
    v_add_f32_dpp v224, v224, v224 row_bcast:31 row_mask:0xc bank_mask:0xf
    v_add_f32_dpp v236, v236, v236 row_bcast:31 row_mask:0xc bank_mask:0xf
    v_readlane_b32 s69, v224, 63
    v_readlane_b32 s70, v236, 63
    s_nop 0
    v_mul_f32 v224, s69, v225
    v_mfma_f32_32x32x16_bf16 v[192:207], v[80:83], v[68:71], v[192:207]
    v_mul_f32 v236, s70, v237
    v_cvt_pk_bf16_f32 v224, v224, v224
    v_cvt_pk_bf16_f32 v236, v236, v236
    v_and_b32 v224, 0xffff0000, v224
    v_and_b32 v236, 0xffff0000, v236
    s_waitcnt lgkmcnt(10)
    v_mfma_f32_32x32x16_bf16 v[208:223], v[84:87], v[64:67], v[208:223]
    v_add_f32 v224, 0x3727c5ac, v224
    v_add_f32 v236, 0x3727c5ac, v236
    v_cvt_pk_bf16_f32 v224, v224, v224
    v_cvt_pk_bf16_f32 v236, v236, v236
    v_and_b32 v224, 0xffff0000, v224
    v_and_b32 v236, 0xffff0000, v236
    s_waitcnt lgkmcnt(7)
    v_mfma_f32_32x32x16_bf16 v[112:127], v[96:99], v[88:91], v[112:127]
    ds_read_b128 v[64:67], v10
    ds_read_b64_tr_b16 v[72:73], v16 offset:14336
    ds_read_b64_tr_b16 v[74:75], v16 offset:16128
    s_waitcnt lgkmcnt(9)
    v_mfma_f32_32x32x16_bf16 v[128:143], v[96:99], v[92:95], v[128:143]
    ds_read_b128 v[68:71], v14
    ds_read_b64_tr_b16 v[76:77], v17 offset:14336
    ds_read_b64_tr_b16 v[78:79], v17 offset:16128
    s_waitcnt lgkmcnt(10)
    v_mfma_f32_32x32x16_bf16 v[144:159], v[100:103], v[88:91], v[144:159]
    ds_read_b64_tr_b16 v[80:81], v18 offset:14336
    ds_read_b64_tr_b16 v[82:83], v18 offset:16128
    ds_read_b64_tr_b16 v[84:85], v19 offset:14336
    v_mfma_f32_32x32x16_bf16 v[160:175], v[100:103], v[92:95], v[160:175]
    ds_read_b64_tr_b16 v[86:87], v19 offset:16128
    v_add_u32 v10, 0xfffea000, v10
    v_add_u32 v14, 0xfffea000, v14
    v_sqrt_f32 v224, v224
    v_sqrt_f32 v236, v236
    s_waitcnt lgkmcnt(12)
    v_mfma_f32_32x32x16_bf16 v[176:191], v[104:107], v[88:91], v[176:191]
    v_cvt_pk_bf16_f32 v224, v226, v224
    v_cvt_pk_bf16_f32 v236, v238, v236
    v_mov_b32 v225, v236
    ds_write_b64 v5, v[224:225] offset:31744
    v_mfma_f32_32x32x16_bf16 v[192:207], v[104:107], v[92:95], v[192:207]
    s_waitcnt lgkmcnt(11)
    v_mfma_f32_32x32x16_bf16 v[208:223], v[108:111], v[88:91], v[208:223]
    s_waitcnt lgkmcnt(8)
    v_mfma_f32_32x32x16_bf16 v[112:127], v[72:75], v[64:67], v[112:127]
    ds_read_b128 v[88:91], v11
    ds_read_b64_tr_b16 v[96:97], v16 offset:21504
    ds_read_b64_tr_b16 v[98:99], v16 offset:23296
    s_waitcnt lgkmcnt(10)
    v_mfma_f32_32x32x16_bf16 v[128:143], v[72:75], v[68:71], v[128:143]
    ds_read_b128 v[92:95], v15
    ds_read_b64_tr_b16 v[100:101], v17 offset:21504
    ds_read_b64_tr_b16 v[102:103], v17 offset:23296
    s_waitcnt lgkmcnt(11)
    v_mfma_f32_32x32x16_bf16 v[144:159], v[76:79], v[64:67], v[144:159]
    ds_read_b64_tr_b16 v[104:105], v18 offset:21504
    ds_read_b64_tr_b16 v[106:107], v18 offset:23296
    ds_read_b64_tr_b16 v[108:109], v19 offset:21504
    v_mfma_f32_32x32x16_bf16 v[160:175], v[76:79], v[68:71], v[160:175]
    ds_read_b64_tr_b16 v[110:111], v19 offset:23296
    v_add_u32 v11, 0xfffea000, v11
    v_add_u32 v15, 0xfffea000, v15
    v_add_u32 v16, 0xfffea000, v16
    v_add_u32 v17, 0xfffea000, v17
    s_waitcnt lgkmcnt(13)
    v_mfma_f32_32x32x16_bf16 v[176:191], v[80:83], v[64:67], v[176:191]
    v_add_u32 v18, 0xfffea000, v18
    v_add_u32 v19, 0xfffea000, v19
    v_mfma_f32_32x32x16_bf16 v[192:207], v[80:83], v[68:71], v[192:207]
    s_waitcnt lgkmcnt(11)
    v_mfma_f32_32x32x16_bf16 v[208:223], v[84:87], v[64:67], v[208:223]
    s_waitcnt lgkmcnt(0)
    v_mfma_f32_32x32x16_bf16 v[112:127], v[96:99], v[88:91], v[112:127]
    s_barrier
    ds_read_b128 v[64:67], v8
    ds_read_b64_tr_b16 v[72:73], v16 offset:0
    ds_read_b64_tr_b16 v[74:75], v16 offset:1792
    v_mfma_f32_32x32x16_bf16 v[128:143], v[96:99], v[92:95], v[128:143]
    ds_read_b128 v[68:71], v12
    ds_read_b64_tr_b16 v[76:77], v17 offset:0
    ds_read_b64_tr_b16 v[78:79], v17 offset:1792
    v_mfma_f32_32x32x16_bf16 v[144:159], v[100:103], v[88:91], v[144:159]
    ds_read_b64_tr_b16 v[80:81], v18 offset:0
    ds_read_b64_tr_b16 v[82:83], v18 offset:1792
    ds_read_b64_tr_b16 v[84:85], v19 offset:0
    v_mfma_f32_32x32x16_bf16 v[160:175], v[100:103], v[92:95], v[160:175]
    ds_read_b64_tr_b16 v[86:87], v19 offset:1792
    v_add_u32 v8, 0xb000, v8
    v_add_u32 v12, 0xb000, v12
    v_mfma_f32_32x32x16_bf16 v[176:191], v[104:107], v[88:91], v[176:191]
    v_mfma_f32_32x32x16_bf16 v[192:207], v[104:107], v[92:95], v[192:207]
    v_mfma_f32_32x32x16_bf16 v[208:223], v[108:111], v[88:91], v[208:223]
    s_waitcnt lgkmcnt(7)
    v_mfma_f32_32x32x16_bf16 v[112:127], v[72:75], v[64:67], v[112:127]
    ds_read_b128 v[88:91], v9
    ds_read_b64_tr_b16 v[96:97], v16 offset:7168
    ds_read_b64_tr_b16 v[98:99], v16 offset:8960
    s_waitcnt lgkmcnt(9)
    v_mfma_f32_32x32x16_bf16 v[128:143], v[72:75], v[68:71], v[128:143]
    ds_read_b128 v[92:95], v13
    ds_read_b64_tr_b16 v[100:101], v17 offset:7168
    ds_read_b64_tr_b16 v[102:103], v17 offset:8960
    s_waitcnt lgkmcnt(10)
    v_mfma_f32_32x32x16_bf16 v[144:159], v[76:79], v[64:67], v[144:159]
    ds_read_b64_tr_b16 v[104:105], v18 offset:7168
    ds_read_b64_tr_b16 v[106:107], v18 offset:8960
    ds_read_b64_tr_b16 v[108:109], v19 offset:7168
    v_mfma_f32_32x32x16_bf16 v[160:175], v[76:79], v[68:71], v[160:175]
    ds_read_b64_tr_b16 v[110:111], v19 offset:8960
    v_add_u32 v9, 0xb000, v9
    v_add_u32 v13, 0xb000, v13
    s_waitcnt lgkmcnt(12)
    v_mfma_f32_32x32x16_bf16 v[176:191], v[80:83], v[64:67], v[176:191]
    v_mfma_f32_32x32x16_bf16 v[192:207], v[80:83], v[68:71], v[192:207]
    s_waitcnt lgkmcnt(10)
    v_mfma_f32_32x32x16_bf16 v[208:223], v[84:87], v[64:67], v[208:223]
    s_waitcnt lgkmcnt(7)
    v_mfma_f32_32x32x16_bf16 v[112:127], v[96:99], v[88:91], v[112:127]
    ds_read_b128 v[64:67], v10
    ds_read_b64_tr_b16 v[72:73], v16 offset:14336
    ds_read_b64_tr_b16 v[74:75], v16 offset:16128
    s_waitcnt lgkmcnt(9)
    v_mfma_f32_32x32x16_bf16 v[128:143], v[96:99], v[92:95], v[128:143]
    ds_read_b128 v[68:71], v14
    ds_read_b64_tr_b16 v[76:77], v17 offset:14336
    ds_read_b64_tr_b16 v[78:79], v17 offset:16128
    s_waitcnt lgkmcnt(10)
    v_mfma_f32_32x32x16_bf16 v[144:159], v[100:103], v[88:91], v[144:159]
    ds_read_b64_tr_b16 v[80:81], v18 offset:14336
    ds_read_b64_tr_b16 v[82:83], v18 offset:16128
    ds_read_b64_tr_b16 v[84:85], v19 offset:14336
    v_mfma_f32_32x32x16_bf16 v[160:175], v[100:103], v[92:95], v[160:175]
    ds_read_b64_tr_b16 v[86:87], v19 offset:16128
    v_add_u32 v10, 0xb000, v10
    v_add_u32 v14, 0xb000, v14
    s_waitcnt lgkmcnt(12)
    v_mfma_f32_32x32x16_bf16 v[176:191], v[104:107], v[88:91], v[176:191]
    v_mfma_f32_32x32x16_bf16 v[192:207], v[104:107], v[92:95], v[192:207]
    s_waitcnt lgkmcnt(10)
    v_mfma_f32_32x32x16_bf16 v[208:223], v[108:111], v[88:91], v[208:223]
    s_waitcnt lgkmcnt(7)
    v_mfma_f32_32x32x16_bf16 v[112:127], v[72:75], v[64:67], v[112:127]
    ds_read_b128 v[88:91], v11
    ds_read_b64_tr_b16 v[96:97], v16 offset:21504
    ds_read_b64_tr_b16 v[98:99], v16 offset:23296
    s_waitcnt lgkmcnt(9)
    v_mfma_f32_32x32x16_bf16 v[128:143], v[72:75], v[68:71], v[128:143]
    ds_read_b128 v[92:95], v15
    ds_read_b64_tr_b16 v[100:101], v17 offset:21504
    ds_read_b64_tr_b16 v[102:103], v17 offset:23296
    s_waitcnt lgkmcnt(10)
    v_mfma_f32_32x32x16_bf16 v[144:159], v[76:79], v[64:67], v[144:159]
    ds_read_b64_tr_b16 v[104:105], v18 offset:21504
    ds_read_b64_tr_b16 v[106:107], v18 offset:23296
    ds_read_b64_tr_b16 v[108:109], v19 offset:21504
    v_mfma_f32_32x32x16_bf16 v[160:175], v[76:79], v[68:71], v[160:175]
    ds_read_b64_tr_b16 v[110:111], v19 offset:23296
    v_add_u32 v11, 0xb000, v11
    v_add_u32 v15, 0xb000, v15
    v_add_u32 v16, 0xb000, v16
    v_add_u32 v17, 0xb000, v17
    s_waitcnt lgkmcnt(12)
    v_mfma_f32_32x32x16_bf16 v[176:191], v[80:83], v[64:67], v[176:191]
    v_add_u32 v18, 0xb000, v18
    v_add_u32 v19, 0xb000, v19
    v_mfma_f32_32x32x16_bf16 v[192:207], v[80:83], v[68:71], v[192:207]
    s_waitcnt lgkmcnt(10)
    v_mfma_f32_32x32x16_bf16 v[208:223], v[84:87], v[64:67], v[208:223]
    s_waitcnt lgkmcnt(0)
    v_mfma_f32_32x32x16_bf16 v[112:127], v[96:99], v[88:91], v[112:127]
    s_barrier
    ds_read_b128 v[64:67], v8
    ds_read_b64_tr_b16 v[72:73], v16 offset:0
    ds_read_b64_tr_b16 v[74:75], v16 offset:1792
    v_mfma_f32_32x32x16_bf16 v[128:143], v[96:99], v[92:95], v[128:143]
    ds_read_b128 v[68:71], v12
    ds_read_b64_tr_b16 v[76:77], v17 offset:0
    ds_read_b64_tr_b16 v[78:79], v17 offset:1792
    v_mfma_f32_32x32x16_bf16 v[144:159], v[100:103], v[88:91], v[144:159]
    ds_read_b64_tr_b16 v[80:81], v18 offset:0
    ds_read_b64_tr_b16 v[82:83], v18 offset:1792
    ds_read_b64_tr_b16 v[84:85], v19 offset:0
    v_mfma_f32_32x32x16_bf16 v[160:175], v[100:103], v[92:95], v[160:175]
    ds_read_b64_tr_b16 v[86:87], v19 offset:1792
    v_add_u32 v8, 0xb000, v8
    v_add_u32 v12, 0xb000, v12
    v_mfma_f32_32x32x16_bf16 v[176:191], v[104:107], v[88:91], v[176:191]
    v_mfma_f32_32x32x16_bf16 v[192:207], v[104:107], v[92:95], v[192:207]
    v_mfma_f32_32x32x16_bf16 v[208:223], v[108:111], v[88:91], v[208:223]
    s_waitcnt lgkmcnt(7)
    v_mfma_f32_32x32x16_bf16 v[112:127], v[72:75], v[64:67], v[112:127]
    ds_read_b128 v[88:91], v9
    ds_read_b64_tr_b16 v[96:97], v16 offset:7168
    ds_read_b64_tr_b16 v[98:99], v16 offset:8960
    s_waitcnt lgkmcnt(9)
    v_mfma_f32_32x32x16_bf16 v[128:143], v[72:75], v[68:71], v[128:143]
    ds_read_b128 v[92:95], v13
    ds_read_b64_tr_b16 v[100:101], v17 offset:7168
    ds_read_b64_tr_b16 v[102:103], v17 offset:8960
    s_waitcnt lgkmcnt(10)
    v_mfma_f32_32x32x16_bf16 v[144:159], v[76:79], v[64:67], v[144:159]
    ds_read_b64_tr_b16 v[104:105], v18 offset:7168
    ds_read_b64_tr_b16 v[106:107], v18 offset:8960
    ds_read_b64_tr_b16 v[108:109], v19 offset:7168
    v_mfma_f32_32x32x16_bf16 v[160:175], v[76:79], v[68:71], v[160:175]
    ds_read_b64_tr_b16 v[110:111], v19 offset:8960
    v_add_u32 v9, 0xb000, v9
    v_add_u32 v13, 0xb000, v13
    s_waitcnt lgkmcnt(12)
    v_mfma_f32_32x32x16_bf16 v[176:191], v[80:83], v[64:67], v[176:191]
    v_mfma_f32_32x32x16_bf16 v[192:207], v[80:83], v[68:71], v[192:207]
    s_waitcnt lgkmcnt(10)
    v_mfma_f32_32x32x16_bf16 v[208:223], v[84:87], v[64:67], v[208:223]
    s_waitcnt lgkmcnt(7)
    v_mfma_f32_32x32x16_bf16 v[112:127], v[96:99], v[88:91], v[112:127]
    ds_read_b128 v[64:67], v10
    ds_read_b64_tr_b16 v[72:73], v16 offset:14336
    ds_read_b64_tr_b16 v[74:75], v16 offset:16128
    s_waitcnt lgkmcnt(9)
    v_mfma_f32_32x32x16_bf16 v[128:143], v[96:99], v[92:95], v[128:143]
    ds_read_b128 v[68:71], v14
    ds_read_b64_tr_b16 v[76:77], v17 offset:14336
    ds_read_b64_tr_b16 v[78:79], v17 offset:16128
    s_waitcnt lgkmcnt(10)
    v_mfma_f32_32x32x16_bf16 v[144:159], v[100:103], v[88:91], v[144:159]
    ds_read_b64_tr_b16 v[80:81], v18 offset:14336
    ds_read_b64_tr_b16 v[82:83], v18 offset:16128
    ds_read_b64_tr_b16 v[84:85], v19 offset:14336
    v_mfma_f32_32x32x16_bf16 v[160:175], v[100:103], v[92:95], v[160:175]
    ds_read_b64_tr_b16 v[86:87], v19 offset:16128
    v_add_u32 v10, 0xb000, v10
    v_add_u32 v14, 0xb000, v14
    s_waitcnt lgkmcnt(12)
    v_mfma_f32_32x32x16_bf16 v[176:191], v[104:107], v[88:91], v[176:191]
    v_mfma_f32_32x32x16_bf16 v[192:207], v[104:107], v[92:95], v[192:207]
    s_waitcnt lgkmcnt(10)
    v_mfma_f32_32x32x16_bf16 v[208:223], v[108:111], v[88:91], v[208:223]
    s_waitcnt lgkmcnt(7)
    v_mfma_f32_32x32x16_bf16 v[112:127], v[72:75], v[64:67], v[112:127]
    ds_read_b128 v[88:91], v11
    ds_read_b64_tr_b16 v[96:97], v16 offset:21504
    ds_read_b64_tr_b16 v[98:99], v16 offset:23296
    s_waitcnt lgkmcnt(9)
    v_mfma_f32_32x32x16_bf16 v[128:143], v[72:75], v[68:71], v[128:143]
    ds_read_b128 v[92:95], v15
    ds_read_b64_tr_b16 v[100:101], v17 offset:21504
    ds_read_b64_tr_b16 v[102:103], v17 offset:23296
    s_waitcnt lgkmcnt(10)
    v_mfma_f32_32x32x16_bf16 v[144:159], v[76:79], v[64:67], v[144:159]
    ds_read_b64_tr_b16 v[104:105], v18 offset:21504
    ds_read_b64_tr_b16 v[106:107], v18 offset:23296
    ds_read_b64_tr_b16 v[108:109], v19 offset:21504
    v_mfma_f32_32x32x16_bf16 v[160:175], v[76:79], v[68:71], v[160:175]
    ds_read_b64_tr_b16 v[110:111], v19 offset:23296
    v_add_u32 v11, 0xb000, v11
    v_add_u32 v15, 0xb000, v15
    v_add_u32 v16, 0xb000, v16
    v_add_u32 v17, 0xb000, v17
    s_waitcnt lgkmcnt(12)
    v_mfma_f32_32x32x16_bf16 v[176:191], v[80:83], v[64:67], v[176:191]
    v_add_u32 v18, 0xb000, v18
    v_add_u32 v19, 0xb000, v19
    v_mfma_f32_32x32x16_bf16 v[192:207], v[80:83], v[68:71], v[192:207]
    s_waitcnt lgkmcnt(10)
    v_mfma_f32_32x32x16_bf16 v[208:223], v[84:87], v[64:67], v[208:223]
    s_waitcnt lgkmcnt(0)
    v_mfma_f32_32x32x16_bf16 v[112:127], v[96:99], v[88:91], v[112:127]
    s_barrier
    ds_read_b128 v[64:67], v8
    ds_read_b64_tr_b16 v[72:73], v16 offset:0
    ds_read_b64_tr_b16 v[74:75], v16 offset:1792
    v_mfma_f32_32x32x16_bf16 v[128:143], v[96:99], v[92:95], v[128:143]
    ds_read_b128 v[68:71], v12
    ds_read_b64_tr_b16 v[76:77], v17 offset:0
    ds_read_b64_tr_b16 v[78:79], v17 offset:1792
    v_mfma_f32_32x32x16_bf16 v[144:159], v[100:103], v[88:91], v[144:159]
    ds_read_b64_tr_b16 v[80:81], v18 offset:0
    ds_read_b64_tr_b16 v[82:83], v18 offset:1792
    ds_read_b64_tr_b16 v[84:85], v19 offset:0
    v_mfma_f32_32x32x16_bf16 v[160:175], v[100:103], v[92:95], v[160:175]
    ds_read_b64_tr_b16 v[86:87], v19 offset:1792
    v_add_u32 v8, 0xfffea000, v8
    v_add_u32 v12, 0xfffea000, v12
    v_mfma_f32_32x32x16_bf16 v[176:191], v[104:107], v[88:91], v[176:191]
    v_mfma_f32_32x32x16_bf16 v[192:207], v[104:107], v[92:95], v[192:207]
    v_mfma_f32_32x32x16_bf16 v[208:223], v[108:111], v[88:91], v[208:223]
    s_waitcnt lgkmcnt(7)
    v_mfma_f32_32x32x16_bf16 v[112:127], v[72:75], v[64:67], v[112:127]
    ds_read_b128 v[88:91], v9
    ds_read_b64_tr_b16 v[96:97], v16 offset:7168
    ds_read_b64_tr_b16 v[98:99], v16 offset:8960
    s_waitcnt lgkmcnt(9)
    v_mfma_f32_32x32x16_bf16 v[128:143], v[72:75], v[68:71], v[128:143]
    ds_read_b128 v[92:95], v13
    ds_read_b64_tr_b16 v[100:101], v17 offset:7168
    ds_read_b64_tr_b16 v[102:103], v17 offset:8960
    s_waitcnt lgkmcnt(10)
    v_mfma_f32_32x32x16_bf16 v[144:159], v[76:79], v[64:67], v[144:159]
    ds_read_b64_tr_b16 v[104:105], v18 offset:7168
    ds_read_b64_tr_b16 v[106:107], v18 offset:8960
    ds_read_b64_tr_b16 v[108:109], v19 offset:7168
    v_mfma_f32_32x32x16_bf16 v[160:175], v[76:79], v[68:71], v[160:175]
    ds_read_b64_tr_b16 v[110:111], v19 offset:8960
    v_add_u32 v9, 0xfffea000, v9
    v_add_u32 v13, 0xfffea000, v13
    s_waitcnt lgkmcnt(12)
    v_mfma_f32_32x32x16_bf16 v[176:191], v[80:83], v[64:67], v[176:191]
    v_mfma_f32_32x32x16_bf16 v[192:207], v[80:83], v[68:71], v[192:207]
    s_waitcnt lgkmcnt(10)
    v_mfma_f32_32x32x16_bf16 v[208:223], v[84:87], v[64:67], v[208:223]
    s_waitcnt lgkmcnt(7)
    v_mfma_f32_32x32x16_bf16 v[112:127], v[96:99], v[88:91], v[112:127]
    ds_read_b128 v[64:67], v10
    ds_read_b64_tr_b16 v[72:73], v16 offset:14336
    ds_read_b64_tr_b16 v[74:75], v16 offset:16128
    s_waitcnt lgkmcnt(9)
    v_mfma_f32_32x32x16_bf16 v[128:143], v[96:99], v[92:95], v[128:143]
    ds_read_b128 v[68:71], v14
    ds_read_b64_tr_b16 v[76:77], v17 offset:14336
    ds_read_b64_tr_b16 v[78:79], v17 offset:16128
    s_waitcnt lgkmcnt(10)
    v_mfma_f32_32x32x16_bf16 v[144:159], v[100:103], v[88:91], v[144:159]
    ds_read_b64_tr_b16 v[80:81], v18 offset:14336
    ds_read_b64_tr_b16 v[82:83], v18 offset:16128
    ds_read_b64_tr_b16 v[84:85], v19 offset:14336
    v_mfma_f32_32x32x16_bf16 v[160:175], v[100:103], v[92:95], v[160:175]
    ds_read_b64_tr_b16 v[86:87], v19 offset:16128
    v_add_u32 v10, 0xfffea000, v10
    v_add_u32 v14, 0xfffea000, v14
    s_waitcnt lgkmcnt(12)
    v_mfma_f32_32x32x16_bf16 v[176:191], v[104:107], v[88:91], v[176:191]
    v_mfma_f32_32x32x16_bf16 v[192:207], v[104:107], v[92:95], v[192:207]
    s_waitcnt lgkmcnt(10)
    v_mfma_f32_32x32x16_bf16 v[208:223], v[108:111], v[88:91], v[208:223]
    s_waitcnt lgkmcnt(7)
    v_mfma_f32_32x32x16_bf16 v[112:127], v[72:75], v[64:67], v[112:127]
    ds_read_b128 v[88:91], v11
    ds_read_b64_tr_b16 v[96:97], v16 offset:21504
    ds_read_b64_tr_b16 v[98:99], v16 offset:23296
    s_waitcnt lgkmcnt(9)
    v_mfma_f32_32x32x16_bf16 v[128:143], v[72:75], v[68:71], v[128:143]
    ds_read_b128 v[92:95], v15
    ds_read_b64_tr_b16 v[100:101], v17 offset:21504
    ds_read_b64_tr_b16 v[102:103], v17 offset:23296
    s_waitcnt lgkmcnt(10)
    v_mfma_f32_32x32x16_bf16 v[144:159], v[76:79], v[64:67], v[144:159]
    ds_read_b64_tr_b16 v[104:105], v18 offset:21504
    ds_read_b64_tr_b16 v[106:107], v18 offset:23296
    ds_read_b64_tr_b16 v[108:109], v19 offset:21504
    v_mfma_f32_32x32x16_bf16 v[160:175], v[76:79], v[68:71], v[160:175]
    ds_read_b64_tr_b16 v[110:111], v19 offset:23296
    v_add_u32 v11, 0xfffea000, v11
    v_add_u32 v15, 0xfffea000, v15
    v_add_u32 v16, 0xfffea000, v16
    v_add_u32 v17, 0xfffea000, v17
    s_waitcnt lgkmcnt(12)
    v_mfma_f32_32x32x16_bf16 v[176:191], v[80:83], v[64:67], v[176:191]
    v_add_u32 v18, 0xfffea000, v18
    v_add_u32 v19, 0xfffea000, v19
    v_mfma_f32_32x32x16_bf16 v[192:207], v[80:83], v[68:71], v[192:207]
    s_waitcnt lgkmcnt(10)
    v_mfma_f32_32x32x16_bf16 v[208:223], v[84:87], v[64:67], v[208:223]
    s_waitcnt lgkmcnt(0)
    v_mfma_f32_32x32x16_bf16 v[112:127], v[96:99], v[88:91], v[112:127]
    s_barrier
    ds_read_b128 v[64:67], v8
    ds_read_b64_tr_b16 v[72:73], v16 offset:0
    ds_read_b64_tr_b16 v[74:75], v16 offset:1792
    v_mfma_f32_32x32x16_bf16 v[128:143], v[96:99], v[92:95], v[128:143]
    ds_read_b128 v[68:71], v12
    ds_read_b64_tr_b16 v[76:77], v17 offset:0
    ds_read_b64_tr_b16 v[78:79], v17 offset:1792
    v_mfma_f32_32x32x16_bf16 v[144:159], v[100:103], v[88:91], v[144:159]
    ds_read_b64_tr_b16 v[80:81], v18 offset:0
    ds_read_b64_tr_b16 v[82:83], v18 offset:1792
    ds_read_b64_tr_b16 v[84:85], v19 offset:0
    v_mfma_f32_32x32x16_bf16 v[160:175], v[100:103], v[92:95], v[160:175]
    ds_read_b64_tr_b16 v[86:87], v19 offset:1792
    v_add_u32 v8, 0xb000, v8
    v_add_u32 v12, 0xb000, v12
    v_mfma_f32_32x32x16_bf16 v[176:191], v[104:107], v[88:91], v[176:191]
    v_mfma_f32_32x32x16_bf16 v[192:207], v[104:107], v[92:95], v[192:207]
    v_mfma_f32_32x32x16_bf16 v[208:223], v[108:111], v[88:91], v[208:223]
    s_waitcnt lgkmcnt(7)
    v_mfma_f32_32x32x16_bf16 v[112:127], v[72:75], v[64:67], v[112:127]
    ds_read_b128 v[88:91], v9
    ds_read_b64_tr_b16 v[96:97], v16 offset:7168
    ds_read_b64_tr_b16 v[98:99], v16 offset:8960
    s_waitcnt lgkmcnt(9)
    v_mfma_f32_32x32x16_bf16 v[128:143], v[72:75], v[68:71], v[128:143]
    ds_read_b128 v[92:95], v13
    ds_read_b64_tr_b16 v[100:101], v17 offset:7168
    ds_read_b64_tr_b16 v[102:103], v17 offset:8960
    s_waitcnt lgkmcnt(10)
    v_mfma_f32_32x32x16_bf16 v[144:159], v[76:79], v[64:67], v[144:159]
    ds_read_b64_tr_b16 v[104:105], v18 offset:7168
    ds_read_b64_tr_b16 v[106:107], v18 offset:8960
    ds_read_b64_tr_b16 v[108:109], v19 offset:7168
    v_mfma_f32_32x32x16_bf16 v[160:175], v[76:79], v[68:71], v[160:175]
    ds_read_b64_tr_b16 v[110:111], v19 offset:8960
    v_add_u32 v9, 0xb000, v9
    v_add_u32 v13, 0xb000, v13
    v_and_b32 v48, 31, v1
    s_lshl_b32 s67, s55, 7
    s_add_u32 s67, s67, 131072
    s_waitcnt lgkmcnt(12)
    v_mfma_f32_32x32x16_bf16 v[176:191], v[80:83], v[64:67], v[176:191]
    v_lshl_add_u32 v48, v48, 2, s67
    v_xor_b32 v54, 0x80, v48
    v_and_b32 v55, 15, v1
    v_lshl_add_u32 v55, v55, 2, v2
    v_mfma_f32_32x32x16_bf16 v[192:207], v[80:83], v[68:71], v[192:207]
    s_waitcnt lgkmcnt(10)
    v_mfma_f32_32x32x16_bf16 v[208:223], v[84:87], v[64:67], v[208:223]
    s_waitcnt lgkmcnt(7)
    v_mfma_f32_32x32x16_bf16 v[112:127], v[96:99], v[88:91], v[112:127]
    ds_read_b128 v[64:67], v10
    ds_read_b64_tr_b16 v[72:73], v16 offset:14336
    ds_read_b64_tr_b16 v[74:75], v16 offset:16128
    s_waitcnt lgkmcnt(9)
    v_mfma_f32_32x32x16_bf16 v[128:143], v[96:99], v[92:95], v[128:143]
    ds_read_b128 v[68:71], v14
    ds_read_b64_tr_b16 v[76:77], v17 offset:14336
    ds_read_b64_tr_b16 v[78:79], v17 offset:16128
    s_waitcnt lgkmcnt(10)
    v_mfma_f32_32x32x16_bf16 v[144:159], v[100:103], v[88:91], v[144:159]
    ds_read_b64_tr_b16 v[80:81], v18 offset:14336
    ds_read_b64_tr_b16 v[82:83], v18 offset:16128
    ds_read_b64_tr_b16 v[84:85], v19 offset:14336
    v_mfma_f32_32x32x16_bf16 v[160:175], v[100:103], v[92:95], v[160:175]
    ds_read_b64_tr_b16 v[86:87], v19 offset:16128
    v_add_u32 v10, 0xb000, v10
    v_add_u32 v14, 0xb000, v14
    s_waitcnt lgkmcnt(12)
    v_mfma_f32_32x32x16_bf16 v[176:191], v[104:107], v[88:91], v[176:191]
    v_mfma_f32_32x32x16_bf16 v[192:207], v[104:107], v[92:95], v[192:207]
    s_waitcnt lgkmcnt(10)
    v_mfma_f32_32x32x16_bf16 v[208:223], v[108:111], v[88:91], v[208:223]
    s_waitcnt lgkmcnt(7)
    v_mfma_f32_32x32x16_bf16 v[112:127], v[72:75], v[64:67], v[112:127]
    ds_read_b128 v[88:91], v11
    ds_read_b64_tr_b16 v[96:97], v16 offset:21504
    ds_read_b64_tr_b16 v[98:99], v16 offset:23296
    s_waitcnt lgkmcnt(9)
    v_mfma_f32_32x32x16_bf16 v[128:143], v[72:75], v[68:71], v[128:143]
    ds_read_b128 v[92:95], v15
    ds_read_b64_tr_b16 v[100:101], v17 offset:21504
    ds_read_b64_tr_b16 v[102:103], v17 offset:23296
    s_waitcnt lgkmcnt(10)
    v_mfma_f32_32x32x16_bf16 v[144:159], v[76:79], v[64:67], v[144:159]
    ds_read_b64_tr_b16 v[104:105], v18 offset:21504
    ds_read_b64_tr_b16 v[106:107], v18 offset:23296
    ds_read_b64_tr_b16 v[108:109], v19 offset:21504
    v_mfma_f32_32x32x16_bf16 v[160:175], v[76:79], v[68:71], v[160:175]
    ds_read_b64_tr_b16 v[110:111], v19 offset:23296
    v_add_u32 v11, 0xb000, v11
    v_add_u32 v15, 0xb000, v15
    v_add_u32 v16, 0xb000, v16
    v_add_u32 v17, 0xb000, v17
    s_waitcnt lgkmcnt(12)
    v_mfma_f32_32x32x16_bf16 v[176:191], v[80:83], v[64:67], v[176:191]
    v_add_u32 v18, 0xb000, v18
    v_add_u32 v19, 0xb000, v19
    v_mfma_f32_32x32x16_bf16 v[192:207], v[80:83], v[68:71], v[192:207]
    s_waitcnt lgkmcnt(10)
    v_mfma_f32_32x32x16_bf16 v[208:223], v[84:87], v[64:67], v[208:223]
    s_waitcnt lgkmcnt(0)
    v_mfma_f32_32x32x16_bf16 v[112:127], v[96:99], v[88:91], v[112:127]
    s_barrier
    ds_read_b32 v49, v48 offset:31872
    ds_read_b32 v50, v54 offset:31872
    ds_read_b64 v[52:53], v2 offset:31808
    v_mfma_f32_32x32x16_bf16 v[128:143], v[96:99], v[92:95], v[128:143]
    ds_read_b128 v[224:227], v8
    ds_read_b64_tr_b16 v[64:65], v17 offset:0
    ds_read_b64_tr_b16 v[66:67], v17 offset:1792
    v_mfma_f32_32x32x16_bf16 v[144:159], v[100:103], v[88:91], v[144:159]
    ds_read_b128 v[228:231], v12
    ds_read_b128 v[232:235], v9
    ds_read_b64_tr_b16 v[68:69], v17 offset:7168
    v_mfma_f32_32x32x16_bf16 v[160:175], v[100:103], v[92:95], v[160:175]
    ds_read_b64_tr_b16 v[70:71], v17 offset:8960
    ds_read_b128 v[236:239], v13
    ds_read_b128 v[240:243], v10
    s_waitcnt lgkmcnt(9)
    v_and_b32 v29, 0xffff0000, v49
    v_mfma_f32_32x32x16_bf16 v[176:191], v[104:107], v[88:91], v[176:191]
    ds_read_b64_tr_b16 v[72:73], v17 offset:14336
    ds_read_b64_tr_b16 v[74:75], v17 offset:16128
    ds_read_b128 v[244:247], v14
    v_and_b32 v36, 0xffff, v49
    v_xor_b32 v36, 0x8000, v36
    v_mfma_f32_32x32x16_bf16 v[192:207], v[104:107], v[92:95], v[192:207]
    ds_read_b128 v[248:251], v11
    ds_read_b64_tr_b16 v[76:77], v17 offset:21504
    ds_read_b64_tr_b16 v[78:79], v17 offset:23296
    v_lshl_or_b32 v36, v36, 16, v36
    v_mov_b32 v37, v36
    v_mfma_f32_32x32x16_bf16 v[208:223], v[108:111], v[88:91], v[208:223]
    ds_read_b128 v[252:255], v15
    ds_read_b128 v[80:83], v25
    ds_read_b64_tr_b16 v[84:85], v18 offset:0
    v_mov_b32 v38, v36
    v_mov_b32 v39, v36
    s_waitcnt lgkmcnt(15)
    v_mfma_f32_32x32x16_bf16 v[144:159], v[64:67], v[224:227], v[144:159]
    ds_read_b64_tr_b16 v[86:87], v18 offset:1792
    ds_read_b64_tr_b16 v[88:89], v18 offset:7168
    v_and_b32 v30, 0xffff0000, v50
    v_and_b32 v40, 0xffff, v50
    v_xor_b32 v40, 0x8000, v40
    s_waitcnt lgkmcnt(15)
    v_mfma_f32_32x32x16_bf16 v[160:175], v[64:67], v[228:231], v[160:175]
    ds_read_b64_tr_b16 v[90:91], v18 offset:8960
    ds_read_b64_tr_b16 v[92:93], v18 offset:14336
    v_lshl_or_b32 v40, v40, 16, v40
    v_mov_b32 v41, v40
    v_mov_b32 v42, v40
    s_waitcnt lgkmcnt(15)
    v_mfma_f32_32x32x16_bf16 v[144:159], v[68:71], v[232:235], v[144:159]
    ds_read_b64_tr_b16 v[94:95], v18 offset:16128
    ds_read_b64_tr_b16 v[96:97], v18 offset:21504
    v_mov_b32 v43, v40
    v_rcp_f32 v31, v29
    s_waitcnt lgkmcnt(15)
    v_mfma_f32_32x32x16_bf16 v[160:175], v[68:71], v[236:239], v[160:175]
    ds_read_b64_tr_b16 v[98:99], v18 offset:23296
    ds_read_b128 v[100:103], v26
    v_rcp_f32 v32, v30
    v_readfirstlane_b32 s88, v52
    s_waitcnt lgkmcnt(15)
    v_mfma_f32_32x32x16_bf16 v[144:159], v[72:75], v[240:243], v[144:159]
    ds_read_b64_tr_b16 v[104:105], v16 offset:0
    ds_read_b64_tr_b16 v[106:107], v16 offset:1792
    v_readfirstlane_b32 s89, v53
    v_mul_f32 v34, 0xbfb8aa3b, v31
    v_mul_f32 v35, 0xbfb8aa3b, v32
    s_waitcnt lgkmcnt(15)
    v_mfma_f32_32x32x16_bf16 v[160:175], v[72:75], v[244:247], v[160:175]
    ds_read_b64_tr_b16 v[108:109], v16 offset:7168
    ds_read_b64_tr_b16 v[110:111], v16 offset:8960
    s_waitcnt lgkmcnt(15)
    v_mfma_f32_32x32x16_bf16 v[144:159], v[76:79], v[248:251], v[144:159]
    ds_read_b64_tr_b16 v[64:65], v16 offset:14336
    ds_read_b64_tr_b16 v[66:67], v16 offset:16128
    s_waitcnt lgkmcnt(15)
    v_mfma_f32_32x32x16_bf16 v[160:175], v[76:79], v[252:255], v[160:175]
    ds_read_b64_tr_b16 v[68:69], v16 offset:21504
    ds_read_b64_tr_b16 v[70:71], v16 offset:23296
    v_mfma_f32_32x32x16_bf16 v[144:159], v[80:83], v[36:39], v[144:159]
    ds_read_b128 v[72:75], v24
    ds_read_b64_tr_b16 v[76:77], v19 offset:0
    v_mfma_f32_32x32x16_bf16 v[160:175], v[80:83], v[40:43], v[160:175]
    ds_read_b64_tr_b16 v[78:79], v19 offset:1792
    ds_read_b64_tr_b16 v[80:81], v19 offset:7168
    s_waitcnt lgkmcnt(15)
    v_mfma_f32_32x32x16_bf16 v[176:191], v[84:87], v[224:227], v[176:191]
    ds_read_b64_tr_b16 v[82:83], v19 offset:8960
    v_mfma_f32_32x32x16_bf16 v[192:207], v[84:87], v[228:231], v[192:207]
    ds_read_b64_tr_b16 v[84:85], v19 offset:14336
    ds_read_b64_tr_b16 v[86:87], v19 offset:16128
    s_nop 0
    v_mul_f32 v48, v144, v34
    v_mul_f32 v49, v145, v34
    v_mul_f32 v50, v146, v34
    v_mfma_f32_32x32x16_bf16 v[176:191], v[88:91], v[232:235], v[176:191]
    v_mul_f32 v51, v147, v34
    v_mul_f32 v52, v148, v34
    v_mul_f32 v53, v149, v34
    v_mul_f32 v54, v150, v34
    v_mul_f32 v55, v151, v34
    v_mfma_f32_32x32x16_bf16 v[192:207], v[88:91], v[236:239], v[192:207]
    ds_read_b64_tr_b16 v[88:89], v19 offset:21504
    ds_read_b64_tr_b16 v[90:91], v19 offset:23296
    v_exp_f32 v48, v48
    v_exp_f32 v49, v49
    v_mfma_f32_32x32x16_bf16 v[176:191], v[92:95], v[240:243], v[176:191]
    v_exp_f32 v50, v50
    v_exp_f32 v51, v51
    v_exp_f32 v52, v52
    v_mfma_f32_32x32x16_bf16 v[192:207], v[92:95], v[244:247], v[192:207]
    ds_read_b128 v[92:95], v27
    v_exp_f32 v53, v53
    v_exp_f32 v54, v54
    s_waitcnt lgkmcnt(15)
    v_mfma_f32_32x32x16_bf16 v[176:191], v[96:99], v[248:251], v[176:191]
    v_exp_f32 v55, v55
    v_fma_f32 v48, v48, v29, v29
    v_fma_f32 v49, v49, v29, v29
    v_fma_f32 v50, v50, v29, v29
    v_mfma_f32_32x32x16_bf16 v[192:207], v[96:99], v[252:255], v[192:207]
    v_fma_f32 v51, v51, v29, v29
    v_fma_f32 v52, v52, v29, v29
    v_fma_f32 v53, v53, v29, v29
    v_fma_f32 v54, v54, v29, v29
    v_fma_f32 v55, v55, v29, v29
    v_mfma_f32_32x32x16_bf16 v[176:191], v[100:103], v[36:39], v[176:191]
    v_rcp_f32 v48, v48
    v_rcp_f32 v49, v49
    v_rcp_f32 v50, v50
    v_mfma_f32_32x32x16_bf16 v[192:207], v[100:103], v[40:43], v[192:207]
    v_rcp_f32 v51, v51
    v_rcp_f32 v52, v52
    v_rcp_f32 v53, v53
    v_mfma_f32_32x32x16_bf16 v[112:127], v[104:107], v[224:227], v[112:127]
    v_rcp_f32 v54, v54
    v_rcp_f32 v55, v55
    v_mul_f32 v144, v144, v48
    v_mfma_f32_32x32x16_bf16 v[128:143], v[104:107], v[228:231], v[128:143]
    v_mul_f32 v145, v145, v49
    v_mul_f32 v146, v146, v50
    v_mul_f32 v147, v147, v51
    v_mul_f32 v148, v148, v52
    v_mul_f32 v149, v149, v53
    s_waitcnt lgkmcnt(14)
    v_mfma_f32_32x32x16_bf16 v[112:127], v[108:111], v[232:235], v[112:127]
    v_mul_f32 v150, v150, v54
    v_mul_f32 v151, v151, v55
    v_cvt_pk_bf16_f32 v144, v144, v145
    v_cvt_pk_bf16_f32 v145, v146, v147
    v_cvt_pk_bf16_f32 v146, v148, v149
    v_mfma_f32_32x32x16_bf16 v[128:143], v[108:111], v[236:239], v[128:143]
    v_cvt_pk_bf16_f32 v147, v150, v151
    v_mul_f32 v48, v152, v34
    v_mul_f32 v49, v153, v34
    v_mul_f32 v50, v154, v34
    v_mul_f32 v51, v155, v34
    s_waitcnt lgkmcnt(12)
    v_mfma_f32_32x32x16_bf16 v[112:127], v[64:67], v[240:243], v[112:127]
    v_mul_f32 v52, v156, v34
    v_mul_f32 v53, v157, v34
    v_mul_f32 v54, v158, v34
    v_mul_f32 v55, v159, v34
    v_exp_f32 v48, v48
    v_mfma_f32_32x32x16_bf16 v[128:143], v[64:67], v[244:247], v[128:143]
    v_exp_f32 v49, v49
    v_exp_f32 v50, v50
    v_exp_f32 v51, v51
    s_waitcnt lgkmcnt(10)
    v_mfma_f32_32x32x16_bf16 v[112:127], v[68:71], v[248:251], v[112:127]
    v_exp_f32 v52, v52
    v_exp_f32 v53, v53
    v_exp_f32 v54, v54
    v_mfma_f32_32x32x16_bf16 v[128:143], v[68:71], v[252:255], v[128:143]
    v_exp_f32 v55, v55
    v_fma_f32 v48, v48, v29, v29
    v_fma_f32 v49, v49, v29, v29
    v_fma_f32 v50, v50, v29, v29
    s_waitcnt lgkmcnt(9)
    v_mfma_f32_32x32x16_bf16 v[112:127], v[72:75], v[36:39], v[112:127]
    v_fma_f32 v51, v51, v29, v29
    v_fma_f32 v52, v52, v29, v29
    v_fma_f32 v53, v53, v29, v29
    v_fma_f32 v54, v54, v29, v29
    v_fma_f32 v55, v55, v29, v29
    v_mfma_f32_32x32x16_bf16 v[128:143], v[72:75], v[40:43], v[128:143]
    v_rcp_f32 v48, v48
    v_rcp_f32 v49, v49
    v_rcp_f32 v50, v50
    s_waitcnt lgkmcnt(7)
    v_mfma_f32_32x32x16_bf16 v[208:223], v[76:79], v[224:227], v[208:223]
    v_rcp_f32 v51, v51
    v_rcp_f32 v52, v52
    v_rcp_f32 v53, v53
    s_waitcnt lgkmcnt(5)
    v_mfma_f32_32x32x16_bf16 v[208:223], v[80:83], v[232:235], v[208:223]
    v_rcp_f32 v54, v54
    v_rcp_f32 v55, v55
    v_mul_f32 v152, v152, v48
    s_waitcnt lgkmcnt(3)
    v_mfma_f32_32x32x16_bf16 v[208:223], v[84:87], v[240:243], v[208:223]
    v_mul_f32 v153, v153, v49
    v_mul_f32 v154, v154, v50
    v_mul_f32 v155, v155, v51
    v_mul_f32 v156, v156, v52
    v_mul_f32 v157, v157, v53
    s_waitcnt lgkmcnt(1)
    v_mfma_f32_32x32x16_bf16 v[208:223], v[88:91], v[248:251], v[208:223]
    v_mul_f32 v158, v158, v54
    v_mul_f32 v159, v159, v55
    v_cvt_pk_bf16_f32 v152, v152, v153
    v_cvt_pk_bf16_f32 v153, v154, v155
    v_cvt_pk_bf16_f32 v154, v156, v157
    s_waitcnt lgkmcnt(0)
    v_mfma_f32_32x32x16_bf16 v[208:223], v[92:95], v[36:39], v[208:223]
    v_cvt_pk_bf16_f32 v155, v158, v159
    s_mov_b64 exec, 1
    ds_add_u32 v2, v3 offset:32544
    s_mov_b64 exec, -1
    s_add_u32 s87, s71, 0
    buffer_store_dwordx4 v[144:147], v6, s[16:19], s87 offen offset:0 sc1
    buffer_store_dwordx4 v[152:155], v6, s[16:19], s87 offen offset:2048 sc1
    v_pk_mul_f32 v[48:49], v[160:161], v[34:35] op_sel:[0,1] op_sel_hi:[1,1]
    v_pk_mul_f32 v[50:51], v[162:163], v[34:35] op_sel:[0,1] op_sel_hi:[1,1]
    v_pk_mul_f32 v[52:53], v[164:165], v[34:35] op_sel:[0,1] op_sel_hi:[1,1]
    v_pk_mul_f32 v[54:55], v[166:167], v[34:35] op_sel:[0,1] op_sel_hi:[1,1]
    v_exp_f32 v48, v48
    v_exp_f32 v49, v49
    v_exp_f32 v50, v50
    v_exp_f32 v51, v51
    v_exp_f32 v52, v52
    v_exp_f32 v53, v53
    v_exp_f32 v54, v54
    v_exp_f32 v55, v55
    v_pk_fma_f32 v[48:49], v[48:49], v[30:31], v[30:31] op_sel:[0,0,0] op_sel_hi:[1,0,0]
    v_pk_fma_f32 v[50:51], v[50:51], v[30:31], v[30:31] op_sel:[0,0,0] op_sel_hi:[1,0,0]
    v_pk_fma_f32 v[52:53], v[52:53], v[30:31], v[30:31] op_sel:[0,0,0] op_sel_hi:[1,0,0]
    v_pk_fma_f32 v[54:55], v[54:55], v[30:31], v[30:31] op_sel:[0,0,0] op_sel_hi:[1,0,0]
    v_rcp_f32 v48, v48
    v_rcp_f32 v49, v49
    v_rcp_f32 v50, v50
    v_rcp_f32 v51, v51
    v_rcp_f32 v52, v52
    v_rcp_f32 v53, v53
    v_rcp_f32 v54, v54
    v_rcp_f32 v55, v55
    v_pk_mul_f32 v[160:161], v[160:161], v[48:49]
    v_pk_mul_f32 v[162:163], v[162:163], v[50:51]
    v_pk_mul_f32 v[164:165], v[164:165], v[52:53]
    v_pk_mul_f32 v[166:167], v[166:167], v[54:55]
    v_cvt_pk_bf16_f32 v160, v160, v161
    v_cvt_pk_bf16_f32 v161, v162, v163
    v_cvt_pk_bf16_f32 v162, v164, v165
    v_cvt_pk_bf16_f32 v163, v166, v167
    v_pk_mul_f32 v[48:49], v[168:169], v[34:35] op_sel:[0,1] op_sel_hi:[1,1]
    v_pk_mul_f32 v[50:51], v[170:171], v[34:35] op_sel:[0,1] op_sel_hi:[1,1]
    v_pk_mul_f32 v[52:53], v[172:173], v[34:35] op_sel:[0,1] op_sel_hi:[1,1]
    v_pk_mul_f32 v[54:55], v[174:175], v[34:35] op_sel:[0,1] op_sel_hi:[1,1]
    v_exp_f32 v48, v48
    v_exp_f32 v49, v49
    v_exp_f32 v50, v50
    v_exp_f32 v51, v51
    v_exp_f32 v52, v52
    v_exp_f32 v53, v53
    v_exp_f32 v54, v54
    v_exp_f32 v55, v55
    v_pk_fma_f32 v[48:49], v[48:49], v[30:31], v[30:31] op_sel:[0,0,0] op_sel_hi:[1,0,0]
    v_pk_fma_f32 v[50:51], v[50:51], v[30:31], v[30:31] op_sel:[0,0,0] op_sel_hi:[1,0,0]
    v_pk_fma_f32 v[52:53], v[52:53], v[30:31], v[30:31] op_sel:[0,0,0] op_sel_hi:[1,0,0]
    v_pk_fma_f32 v[54:55], v[54:55], v[30:31], v[30:31] op_sel:[0,0,0] op_sel_hi:[1,0,0]
    v_rcp_f32 v48, v48
    v_rcp_f32 v49, v49
    v_rcp_f32 v50, v50
    v_rcp_f32 v51, v51
    v_rcp_f32 v52, v52
    v_rcp_f32 v53, v53
    v_rcp_f32 v54, v54
    v_rcp_f32 v55, v55
    v_pk_mul_f32 v[168:169], v[168:169], v[48:49]
    v_pk_mul_f32 v[170:171], v[170:171], v[50:51]
    v_pk_mul_f32 v[172:173], v[172:173], v[52:53]
    v_pk_mul_f32 v[174:175], v[174:175], v[54:55]
    v_cvt_pk_bf16_f32 v168, v168, v169
    v_cvt_pk_bf16_f32 v169, v170, v171
    v_cvt_pk_bf16_f32 v170, v172, v173
    v_cvt_pk_bf16_f32 v171, v174, v175
    s_add_u32 s87, s56, 0
    buffer_store_dwordx4 v[160:163], v6, s[16:19], s87 offen offset:0 sc1
    buffer_store_dwordx4 v[168:171], v6, s[16:19], s87 offen offset:2048 sc1
    v_pk_mul_f32 v[48:49], v[176:177], v[34:35] op_sel:[0,0] op_sel_hi:[1,0]
    v_pk_mul_f32 v[50:51], v[178:179], v[34:35] op_sel:[0,0] op_sel_hi:[1,0]
    v_pk_mul_f32 v[52:53], v[180:181], v[34:35] op_sel:[0,0] op_sel_hi:[1,0]
    v_pk_mul_f32 v[54:55], v[182:183], v[34:35] op_sel:[0,0] op_sel_hi:[1,0]
    v_exp_f32 v48, v48
    v_exp_f32 v49, v49
    v_exp_f32 v50, v50
    v_exp_f32 v51, v51
    v_exp_f32 v52, v52
    v_exp_f32 v53, v53
    v_exp_f32 v54, v54
    v_exp_f32 v55, v55
    v_pk_fma_f32 v[48:49], v[48:49], v[28:29], v[28:29] op_sel:[0,1,1] op_sel_hi:[1,1,1]
    v_pk_fma_f32 v[50:51], v[50:51], v[28:29], v[28:29] op_sel:[0,1,1] op_sel_hi:[1,1,1]
    v_pk_fma_f32 v[52:53], v[52:53], v[28:29], v[28:29] op_sel:[0,1,1] op_sel_hi:[1,1,1]
    v_pk_fma_f32 v[54:55], v[54:55], v[28:29], v[28:29] op_sel:[0,1,1] op_sel_hi:[1,1,1]
    v_rcp_f32 v48, v48
    v_rcp_f32 v49, v49
    v_rcp_f32 v50, v50
    v_rcp_f32 v51, v51
    v_rcp_f32 v52, v52
    v_rcp_f32 v53, v53
    v_rcp_f32 v54, v54
    v_rcp_f32 v55, v55
    v_pk_mul_f32 v[176:177], v[176:177], v[48:49]
    v_pk_mul_f32 v[178:179], v[178:179], v[50:51]
    v_pk_mul_f32 v[180:181], v[180:181], v[52:53]
    v_pk_mul_f32 v[182:183], v[182:183], v[54:55]
    v_cvt_pk_bf16_f32 v176, v176, v177
    v_cvt_pk_bf16_f32 v177, v178, v179
    v_cvt_pk_bf16_f32 v178, v180, v181
    v_cvt_pk_bf16_f32 v179, v182, v183
    v_pk_mul_f32 v[48:49], v[184:185], v[34:35] op_sel:[0,0] op_sel_hi:[1,0]
    v_pk_mul_f32 v[50:51], v[186:187], v[34:35] op_sel:[0,0] op_sel_hi:[1,0]
    v_pk_mul_f32 v[52:53], v[188:189], v[34:35] op_sel:[0,0] op_sel_hi:[1,0]
    v_pk_mul_f32 v[54:55], v[190:191], v[34:35] op_sel:[0,0] op_sel_hi:[1,0]
    v_exp_f32 v48, v48
    v_exp_f32 v49, v49
    v_exp_f32 v50, v50
    v_exp_f32 v51, v51
    v_exp_f32 v52, v52
    v_exp_f32 v53, v53
    v_exp_f32 v54, v54
    v_exp_f32 v55, v55
    v_pk_fma_f32 v[48:49], v[48:49], v[28:29], v[28:29] op_sel:[0,1,1] op_sel_hi:[1,1,1]
    v_pk_fma_f32 v[50:51], v[50:51], v[28:29], v[28:29] op_sel:[0,1,1] op_sel_hi:[1,1,1]
    v_pk_fma_f32 v[52:53], v[52:53], v[28:29], v[28:29] op_sel:[0,1,1] op_sel_hi:[1,1,1]
    v_pk_fma_f32 v[54:55], v[54:55], v[28:29], v[28:29] op_sel:[0,1,1] op_sel_hi:[1,1,1]
    v_rcp_f32 v48, v48
    v_rcp_f32 v49, v49
    v_rcp_f32 v50, v50
    v_rcp_f32 v51, v51
    v_rcp_f32 v52, v52
    v_rcp_f32 v53, v53
    v_rcp_f32 v54, v54
    v_rcp_f32 v55, v55
    v_pk_mul_f32 v[184:185], v[184:185], v[48:49]
    v_pk_mul_f32 v[186:187], v[186:187], v[50:51]
    v_pk_mul_f32 v[188:189], v[188:189], v[52:53]
    v_pk_mul_f32 v[190:191], v[190:191], v[54:55]
    v_cvt_pk_bf16_f32 v184, v184, v185
    v_cvt_pk_bf16_f32 v185, v186, v187
    v_cvt_pk_bf16_f32 v186, v188, v189
    v_cvt_pk_bf16_f32 v187, v190, v191
    s_add_u32 s87, s71, 16384
    buffer_store_dwordx4 v[176:179], v6, s[16:19], s87 offen offset:0 sc1
    buffer_store_dwordx4 v[184:187], v6, s[16:19], s87 offen offset:2048 sc1
    v_pk_mul_f32 v[48:49], v[192:193], v[34:35] op_sel:[0,1] op_sel_hi:[1,1]
    v_pk_mul_f32 v[50:51], v[194:195], v[34:35] op_sel:[0,1] op_sel_hi:[1,1]
    v_pk_mul_f32 v[52:53], v[196:197], v[34:35] op_sel:[0,1] op_sel_hi:[1,1]
    v_pk_mul_f32 v[54:55], v[198:199], v[34:35] op_sel:[0,1] op_sel_hi:[1,1]
    v_exp_f32 v48, v48
    v_exp_f32 v49, v49
    v_exp_f32 v50, v50
    v_exp_f32 v51, v51
    v_exp_f32 v52, v52
    v_exp_f32 v53, v53
    v_exp_f32 v54, v54
    v_exp_f32 v55, v55
    v_pk_fma_f32 v[48:49], v[48:49], v[30:31], v[30:31] op_sel:[0,0,0] op_sel_hi:[1,0,0]
    v_pk_fma_f32 v[50:51], v[50:51], v[30:31], v[30:31] op_sel:[0,0,0] op_sel_hi:[1,0,0]
    v_pk_fma_f32 v[52:53], v[52:53], v[30:31], v[30:31] op_sel:[0,0,0] op_sel_hi:[1,0,0]
    v_pk_fma_f32 v[54:55], v[54:55], v[30:31], v[30:31] op_sel:[0,0,0] op_sel_hi:[1,0,0]
    v_rcp_f32 v48, v48
    v_rcp_f32 v49, v49
    v_rcp_f32 v50, v50
    v_rcp_f32 v51, v51
    v_rcp_f32 v52, v52
    v_rcp_f32 v53, v53
    v_rcp_f32 v54, v54
    v_rcp_f32 v55, v55
    v_pk_mul_f32 v[192:193], v[192:193], v[48:49]
    v_pk_mul_f32 v[194:195], v[194:195], v[50:51]
    v_pk_mul_f32 v[196:197], v[196:197], v[52:53]
    v_pk_mul_f32 v[198:199], v[198:199], v[54:55]
    v_cvt_pk_bf16_f32 v192, v192, v193
    v_cvt_pk_bf16_f32 v193, v194, v195
    v_cvt_pk_bf16_f32 v194, v196, v197
    v_cvt_pk_bf16_f32 v195, v198, v199
    v_pk_mul_f32 v[48:49], v[200:201], v[34:35] op_sel:[0,1] op_sel_hi:[1,1]
    v_pk_mul_f32 v[50:51], v[202:203], v[34:35] op_sel:[0,1] op_sel_hi:[1,1]
    v_pk_mul_f32 v[52:53], v[204:205], v[34:35] op_sel:[0,1] op_sel_hi:[1,1]
    v_pk_mul_f32 v[54:55], v[206:207], v[34:35] op_sel:[0,1] op_sel_hi:[1,1]
    v_exp_f32 v48, v48
    v_exp_f32 v49, v49
    v_exp_f32 v50, v50
    v_exp_f32 v51, v51
    v_exp_f32 v52, v52
    v_exp_f32 v53, v53
    v_exp_f32 v54, v54
    v_exp_f32 v55, v55
    v_pk_fma_f32 v[48:49], v[48:49], v[30:31], v[30:31] op_sel:[0,0,0] op_sel_hi:[1,0,0]
    v_pk_fma_f32 v[50:51], v[50:51], v[30:31], v[30:31] op_sel:[0,0,0] op_sel_hi:[1,0,0]
    v_pk_fma_f32 v[52:53], v[52:53], v[30:31], v[30:31] op_sel:[0,0,0] op_sel_hi:[1,0,0]
    v_pk_fma_f32 v[54:55], v[54:55], v[30:31], v[30:31] op_sel:[0,0,0] op_sel_hi:[1,0,0]
    v_rcp_f32 v48, v48
    v_rcp_f32 v49, v49
    v_rcp_f32 v50, v50
    v_rcp_f32 v51, v51
    v_rcp_f32 v52, v52
    v_rcp_f32 v53, v53
    v_rcp_f32 v54, v54
    v_rcp_f32 v55, v55
    v_pk_mul_f32 v[200:201], v[200:201], v[48:49]
    v_pk_mul_f32 v[202:203], v[202:203], v[50:51]
    v_pk_mul_f32 v[204:205], v[204:205], v[52:53]
    v_pk_mul_f32 v[206:207], v[206:207], v[54:55]
    v_cvt_pk_bf16_f32 v200, v200, v201
    v_cvt_pk_bf16_f32 v201, v202, v203
    v_cvt_pk_bf16_f32 v202, v204, v205
    v_cvt_pk_bf16_f32 v203, v206, v207
    s_add_u32 s87, s56, 16384
    buffer_store_dwordx4 v[192:195], v6, s[16:19], s87 offen offset:0 sc1
    buffer_store_dwordx4 v[200:203], v6, s[16:19], s87 offen offset:2048 sc1
    v_pk_mul_f32 v[48:49], v[112:113], v[34:35] op_sel:[0,0] op_sel_hi:[1,0]
    v_pk_mul_f32 v[50:51], v[114:115], v[34:35] op_sel:[0,0] op_sel_hi:[1,0]
    v_pk_mul_f32 v[52:53], v[116:117], v[34:35] op_sel:[0,0] op_sel_hi:[1,0]
    v_pk_mul_f32 v[54:55], v[118:119], v[34:35] op_sel:[0,0] op_sel_hi:[1,0]
    v_exp_f32 v48, v48
    v_exp_f32 v49, v49
    v_exp_f32 v50, v50
    v_exp_f32 v51, v51
    v_exp_f32 v52, v52
    v_exp_f32 v53, v53
    v_exp_f32 v54, v54
    v_exp_f32 v55, v55
    v_pk_fma_f32 v[48:49], v[48:49], v[28:29], v[28:29] op_sel:[0,1,1] op_sel_hi:[1,1,1]
    v_pk_fma_f32 v[50:51], v[50:51], v[28:29], v[28:29] op_sel:[0,1,1] op_sel_hi:[1,1,1]
    v_pk_fma_f32 v[52:53], v[52:53], v[28:29], v[28:29] op_sel:[0,1,1] op_sel_hi:[1,1,1]
    v_pk_fma_f32 v[54:55], v[54:55], v[28:29], v[28:29] op_sel:[0,1,1] op_sel_hi:[1,1,1]
    v_rcp_f32 v48, v48
    v_rcp_f32 v49, v49
    v_rcp_f32 v50, v50
    v_rcp_f32 v51, v51
    v_rcp_f32 v52, v52
    v_rcp_f32 v53, v53
    v_rcp_f32 v54, v54
    v_rcp_f32 v55, v55
    v_pk_mul_f32 v[112:113], v[112:113], v[48:49]
    v_pk_mul_f32 v[114:115], v[114:115], v[50:51]
    v_pk_mul_f32 v[116:117], v[116:117], v[52:53]
    v_pk_mul_f32 v[118:119], v[118:119], v[54:55]
    v_cvt_pk_bf16_f32 v112, v112, v113
    v_cvt_pk_bf16_f32 v113, v114, v115
    v_cvt_pk_bf16_f32 v114, v116, v117
    v_cvt_pk_bf16_f32 v115, v118, v119
    v_pk_mul_f32 v[48:49], v[120:121], v[34:35] op_sel:[0,0] op_sel_hi:[1,0]
    v_pk_mul_f32 v[50:51], v[122:123], v[34:35] op_sel:[0,0] op_sel_hi:[1,0]
    v_pk_mul_f32 v[52:53], v[124:125], v[34:35] op_sel:[0,0] op_sel_hi:[1,0]
    v_pk_mul_f32 v[54:55], v[126:127], v[34:35] op_sel:[0,0] op_sel_hi:[1,0]
    v_exp_f32 v48, v48
    v_exp_f32 v49, v49
    v_exp_f32 v50, v50
    v_exp_f32 v51, v51
    v_exp_f32 v52, v52
    v_exp_f32 v53, v53
    v_exp_f32 v54, v54
    v_exp_f32 v55, v55
    v_pk_fma_f32 v[48:49], v[48:49], v[28:29], v[28:29] op_sel:[0,1,1] op_sel_hi:[1,1,1]
    v_pk_fma_f32 v[50:51], v[50:51], v[28:29], v[28:29] op_sel:[0,1,1] op_sel_hi:[1,1,1]
    v_pk_fma_f32 v[52:53], v[52:53], v[28:29], v[28:29] op_sel:[0,1,1] op_sel_hi:[1,1,1]
    v_pk_fma_f32 v[54:55], v[54:55], v[28:29], v[28:29] op_sel:[0,1,1] op_sel_hi:[1,1,1]
    v_rcp_f32 v48, v48
    v_rcp_f32 v49, v49
    v_rcp_f32 v50, v50
    v_rcp_f32 v51, v51
    v_rcp_f32 v52, v52
    v_rcp_f32 v53, v53
    v_rcp_f32 v54, v54
    v_rcp_f32 v55, v55
    v_pk_mul_f32 v[120:121], v[120:121], v[48:49]
    v_pk_mul_f32 v[122:123], v[122:123], v[50:51]
    v_pk_mul_f32 v[124:125], v[124:125], v[52:53]
    v_pk_mul_f32 v[126:127], v[126:127], v[54:55]
    v_cvt_pk_bf16_f32 v120, v120, v121
    v_cvt_pk_bf16_f32 v121, v122, v123
    v_cvt_pk_bf16_f32 v122, v124, v125
    v_cvt_pk_bf16_f32 v123, v126, v127
    s_waitcnt vmcnt(4)
    v_mov_b32 v60, s88
    v_mov_b32 v61, s89
    v_mov_b32 v62, 0
    s_mov_b64 exec, 1
    buffer_store_dwordx2 v[60:61], v62, s[16:19], s6 offen offset:128 sc1
    s_mov_b64 exec, -1
    s_add_u32 s87, s71, 32768
    buffer_store_dwordx4 v[112:115], v6, s[16:19], s87 offen offset:0 sc1
    buffer_store_dwordx4 v[120:123], v6, s[16:19], s87 offen offset:2048 sc1
    v_pk_mul_f32 v[48:49], v[128:129], v[34:35] op_sel:[0,1] op_sel_hi:[1,1]
    v_pk_mul_f32 v[50:51], v[130:131], v[34:35] op_sel:[0,1] op_sel_hi:[1,1]
    v_pk_mul_f32 v[52:53], v[132:133], v[34:35] op_sel:[0,1] op_sel_hi:[1,1]
    v_pk_mul_f32 v[54:55], v[134:135], v[34:35] op_sel:[0,1] op_sel_hi:[1,1]
    v_exp_f32 v48, v48
    v_exp_f32 v49, v49
    v_exp_f32 v50, v50
    v_exp_f32 v51, v51
    v_exp_f32 v52, v52
    v_exp_f32 v53, v53
    v_exp_f32 v54, v54
    v_exp_f32 v55, v55
    v_pk_fma_f32 v[48:49], v[48:49], v[30:31], v[30:31] op_sel:[0,0,0] op_sel_hi:[1,0,0]
    v_pk_fma_f32 v[50:51], v[50:51], v[30:31], v[30:31] op_sel:[0,0,0] op_sel_hi:[1,0,0]
    v_pk_fma_f32 v[52:53], v[52:53], v[30:31], v[30:31] op_sel:[0,0,0] op_sel_hi:[1,0,0]
    v_pk_fma_f32 v[54:55], v[54:55], v[30:31], v[30:31] op_sel:[0,0,0] op_sel_hi:[1,0,0]
    v_rcp_f32 v48, v48
    v_rcp_f32 v49, v49
    v_rcp_f32 v50, v50
    v_rcp_f32 v51, v51
    v_rcp_f32 v52, v52
    v_rcp_f32 v53, v53
    v_rcp_f32 v54, v54
    v_rcp_f32 v55, v55
    v_pk_mul_f32 v[128:129], v[128:129], v[48:49]
    v_pk_mul_f32 v[130:131], v[130:131], v[50:51]
    v_pk_mul_f32 v[132:133], v[132:133], v[52:53]
    v_pk_mul_f32 v[134:135], v[134:135], v[54:55]
    v_cvt_pk_bf16_f32 v128, v128, v129
    v_cvt_pk_bf16_f32 v129, v130, v131
    v_cvt_pk_bf16_f32 v130, v132, v133
    v_cvt_pk_bf16_f32 v131, v134, v135
    v_pk_mul_f32 v[48:49], v[136:137], v[34:35] op_sel:[0,1] op_sel_hi:[1,1]
    v_pk_mul_f32 v[50:51], v[138:139], v[34:35] op_sel:[0,1] op_sel_hi:[1,1]
    v_pk_mul_f32 v[52:53], v[140:141], v[34:35] op_sel:[0,1] op_sel_hi:[1,1]
    v_pk_mul_f32 v[54:55], v[142:143], v[34:35] op_sel:[0,1] op_sel_hi:[1,1]
    v_exp_f32 v48, v48
    v_exp_f32 v49, v49
    v_exp_f32 v50, v50
    v_exp_f32 v51, v51
    v_exp_f32 v52, v52
    v_exp_f32 v53, v53
    v_exp_f32 v54, v54
    v_exp_f32 v55, v55
    v_pk_fma_f32 v[48:49], v[48:49], v[30:31], v[30:31] op_sel:[0,0,0] op_sel_hi:[1,0,0]
    v_pk_fma_f32 v[50:51], v[50:51], v[30:31], v[30:31] op_sel:[0,0,0] op_sel_hi:[1,0,0]
    v_pk_fma_f32 v[52:53], v[52:53], v[30:31], v[30:31] op_sel:[0,0,0] op_sel_hi:[1,0,0]
    v_pk_fma_f32 v[54:55], v[54:55], v[30:31], v[30:31] op_sel:[0,0,0] op_sel_hi:[1,0,0]
    v_rcp_f32 v48, v48
    v_rcp_f32 v49, v49
    v_rcp_f32 v50, v50
    v_rcp_f32 v51, v51
    v_rcp_f32 v52, v52
    v_rcp_f32 v53, v53
    v_rcp_f32 v54, v54
    v_rcp_f32 v55, v55
    v_pk_mul_f32 v[136:137], v[136:137], v[48:49]
    v_pk_mul_f32 v[138:139], v[138:139], v[50:51]
    v_pk_mul_f32 v[140:141], v[140:141], v[52:53]
    v_pk_mul_f32 v[142:143], v[142:143], v[54:55]
    v_cvt_pk_bf16_f32 v136, v136, v137
    v_cvt_pk_bf16_f32 v137, v138, v139
    v_cvt_pk_bf16_f32 v138, v140, v141
    v_cvt_pk_bf16_f32 v139, v142, v143
    s_add_u32 s87, s56, 32768
    buffer_store_dwordx4 v[128:131], v6, s[16:19], s87 offen offset:0 sc1
    buffer_store_dwordx4 v[136:139], v6, s[16:19], s87 offen offset:2048 sc1
    v_pk_mul_f32 v[48:49], v[208:209], v[34:35] op_sel:[0,0] op_sel_hi:[1,0]
    v_pk_mul_f32 v[50:51], v[210:211], v[34:35] op_sel:[0,0] op_sel_hi:[1,0]
    v_pk_mul_f32 v[52:53], v[212:213], v[34:35] op_sel:[0,0] op_sel_hi:[1,0]
    v_pk_mul_f32 v[54:55], v[214:215], v[34:35] op_sel:[0,0] op_sel_hi:[1,0]
    v_exp_f32 v48, v48
    v_exp_f32 v49, v49
    v_exp_f32 v50, v50
    v_exp_f32 v51, v51
    v_exp_f32 v52, v52
    v_exp_f32 v53, v53
    v_exp_f32 v54, v54
    v_exp_f32 v55, v55
    v_pk_fma_f32 v[48:49], v[48:49], v[28:29], v[28:29] op_sel:[0,1,1] op_sel_hi:[1,1,1]
    v_pk_fma_f32 v[50:51], v[50:51], v[28:29], v[28:29] op_sel:[0,1,1] op_sel_hi:[1,1,1]
    v_pk_fma_f32 v[52:53], v[52:53], v[28:29], v[28:29] op_sel:[0,1,1] op_sel_hi:[1,1,1]
    v_pk_fma_f32 v[54:55], v[54:55], v[28:29], v[28:29] op_sel:[0,1,1] op_sel_hi:[1,1,1]
    v_rcp_f32 v48, v48
    v_rcp_f32 v49, v49
    v_rcp_f32 v50, v50
    v_rcp_f32 v51, v51
    v_rcp_f32 v52, v52
    v_rcp_f32 v53, v53
    v_rcp_f32 v54, v54
    v_rcp_f32 v55, v55
    v_pk_mul_f32 v[208:209], v[208:209], v[48:49]
    v_pk_mul_f32 v[210:211], v[210:211], v[50:51]
    v_pk_mul_f32 v[212:213], v[212:213], v[52:53]
    v_pk_mul_f32 v[214:215], v[214:215], v[54:55]
    v_cvt_pk_bf16_f32 v208, v208, v209
    v_cvt_pk_bf16_f32 v209, v210, v211
    v_cvt_pk_bf16_f32 v210, v212, v213
    v_cvt_pk_bf16_f32 v211, v214, v215
    v_pk_mul_f32 v[48:49], v[216:217], v[34:35] op_sel:[0,0] op_sel_hi:[1,0]
    v_pk_mul_f32 v[50:51], v[218:219], v[34:35] op_sel:[0,0] op_sel_hi:[1,0]
    v_pk_mul_f32 v[52:53], v[220:221], v[34:35] op_sel:[0,0] op_sel_hi:[1,0]
    v_pk_mul_f32 v[54:55], v[222:223], v[34:35] op_sel:[0,0] op_sel_hi:[1,0]
    v_exp_f32 v48, v48
    v_exp_f32 v49, v49
    v_exp_f32 v50, v50
    v_exp_f32 v51, v51
    v_exp_f32 v52, v52
    v_exp_f32 v53, v53
    v_exp_f32 v54, v54
    v_exp_f32 v55, v55
    v_pk_fma_f32 v[48:49], v[48:49], v[28:29], v[28:29] op_sel:[0,1,1] op_sel_hi:[1,1,1]
    v_pk_fma_f32 v[50:51], v[50:51], v[28:29], v[28:29] op_sel:[0,1,1] op_sel_hi:[1,1,1]
    v_pk_fma_f32 v[52:53], v[52:53], v[28:29], v[28:29] op_sel:[0,1,1] op_sel_hi:[1,1,1]
    v_pk_fma_f32 v[54:55], v[54:55], v[28:29], v[28:29] op_sel:[0,1,1] op_sel_hi:[1,1,1]
    v_rcp_f32 v48, v48
    v_rcp_f32 v49, v49
    v_rcp_f32 v50, v50
    v_rcp_f32 v51, v51
    v_rcp_f32 v52, v52
    v_rcp_f32 v53, v53
    v_rcp_f32 v54, v54
    v_rcp_f32 v55, v55
    v_pk_mul_f32 v[216:217], v[216:217], v[48:49]
    v_pk_mul_f32 v[218:219], v[218:219], v[50:51]
    v_pk_mul_f32 v[220:221], v[220:221], v[52:53]
    v_pk_mul_f32 v[222:223], v[222:223], v[54:55]
    v_cvt_pk_bf16_f32 v216, v216, v217
    v_cvt_pk_bf16_f32 v217, v218, v219
    v_cvt_pk_bf16_f32 v218, v220, v221
    v_cvt_pk_bf16_f32 v219, v222, v223
    s_waitcnt vmcnt(5)
    v_mov_b32 v60, s88
    v_mov_b32 v61, s89
    v_mov_b32 v62, 0
    s_mov_b64 exec, 1
    buffer_store_dwordx2 v[60:61], v62, s[16:19], s6 offen offset:256 sc1
    s_mov_b64 exec, -1
    s_add_u32 s87, s60, 49152
    buffer_store_dwordx4 v[208:211], v6, s[16:19], s87 offen offset:0 sc1
    buffer_store_dwordx4 v[216:219], v6, s[16:19], s87 offen offset:2048 sc1
    s_mov_b64 exec, 1
    ds_add_u32 v2, v3 offset:32584
    s_mov_b64 exec, -1
    s_waitcnt vmcnt(0)
    v_mov_b32 v60, s88
    v_mov_b32 v61, s89
    v_mov_b32 v62, 0
    s_mov_b64 exec, 1
    buffer_store_dwordx2 v[60:61], v62, s[16:19], s6 offen offset:384 sc1
    s_mov_b64 exec, -1
    s_branch L_finA
L_A_att:
    s_waitcnt vmcnt(9)
    s_barrier
    ds_read_b128 v[64:67], v8
    ds_read_b64_tr_b16 v[72:73], v16 offset:0
    ds_read_b64_tr_b16 v[74:75], v16 offset:1792
    ds_read_b128 v[68:71], v12
    ds_read_b64_tr_b16 v[76:77], v17 offset:0
    ds_read_b64_tr_b16 v[78:79], v17 offset:1792
    ds_read_b64_tr_b16 v[80:81], v18 offset:0
    ds_read_b64_tr_b16 v[82:83], v18 offset:1792
    ds_read_b128 v[84:87], v20 offset:0
    s_waitcnt lgkmcnt(6)
    v_mfma_f32_32x32x16_bf16 v[112:127], v[72:75], v[64:67], 0
    ds_read_b128 v[88:91], v9
    ds_read_b64_tr_b16 v[96:97], v16 offset:7168
    ds_read_b64_tr_b16 v[98:99], v16 offset:8960
    s_waitcnt lgkmcnt(8)
    v_mfma_f32_32x32x16_bf16 v[128:143], v[72:75], v[68:71], 0
    ds_read_b128 v[92:95], v13
    ds_read_b64_tr_b16 v[100:101], v17 offset:7168
    ds_read_b64_tr_b16 v[102:103], v17 offset:8960
    s_waitcnt lgkmcnt(9)
    v_mfma_f32_32x32x16_bf16 v[144:159], v[76:79], v[64:67], 0
    ds_read_b64_tr_b16 v[104:105], v18 offset:7168
    ds_read_b64_tr_b16 v[106:107], v18 offset:8960
    ds_read_b128 v[108:111], v21 offset:0
    v_add_u32 v9, 0xb000, v9
    v_add_u32 v13, 0xb000, v13
    v_mfma_f32_32x32x16_bf16 v[160:175], v[76:79], v[68:71], 0
    v_add_u32 v8, 0xb000, v8
    v_add_u32 v12, 0xb000, v12
    s_waitcnt lgkmcnt(10)
    v_mfma_f32_32x32x16_bf16 v[176:191], v[80:83], v[64:67], 0
    v_mfma_f32_32x32x16_bf16 v[192:207], v[80:83], v[68:71], 0
    s_waitcnt lgkmcnt(9)
    v_mfma_f32_32x32x16_bf16 v[208:223], v[76:79], v[84:87], 0
    s_waitcnt lgkmcnt(6)
    v_mfma_f32_32x32x16_bf16 v[112:127], v[96:99], v[88:91], v[112:127]
    s_waitcnt vmcnt(5)
    s_barrier
    ds_read_b128 v[64:67], v10
    ds_read_b64_tr_b16 v[72:73], v16 offset:14336
    ds_read_b64_tr_b16 v[74:75], v16 offset:16128
    s_waitcnt lgkmcnt(8)
    v_mfma_f32_32x32x16_bf16 v[128:143], v[96:99], v[92:95], v[128:143]
    ds_read_b128 v[68:71], v14
    ds_read_b64_tr_b16 v[76:77], v17 offset:14336
    ds_read_b64_tr_b16 v[78:79], v17 offset:16128
    s_waitcnt lgkmcnt(9)
    v_mfma_f32_32x32x16_bf16 v[144:159], v[100:103], v[88:91], v[144:159]
    ds_read_b64_tr_b16 v[80:81], v18 offset:14336
    ds_read_b64_tr_b16 v[82:83], v18 offset:16128
    ds_read_b128 v[84:87], v22 offset:0
    v_add_u32 v10, 0xb000, v10
    v_add_u32 v14, 0xb000, v14
    v_mfma_f32_32x32x16_bf16 v[160:175], v[100:103], v[92:95], v[160:175]
    s_waitcnt lgkmcnt(10)
    v_mfma_f32_32x32x16_bf16 v[176:191], v[104:107], v[88:91], v[176:191]
    v_mfma_f32_32x32x16_bf16 v[192:207], v[104:107], v[92:95], v[192:207]
    s_waitcnt lgkmcnt(9)
    v_mfma_f32_32x32x16_bf16 v[208:223], v[100:103], v[108:111], v[208:223]
    s_waitcnt lgkmcnt(6)
    v_mfma_f32_32x32x16_bf16 v[112:127], v[72:75], v[64:67], v[112:127]
    ds_read_b128 v[88:91], v11
    ds_read_b64_tr_b16 v[96:97], v16 offset:21504
    ds_read_b64_tr_b16 v[98:99], v16 offset:23296
    s_waitcnt lgkmcnt(8)
    v_mfma_f32_32x32x16_bf16 v[128:143], v[72:75], v[68:71], v[128:143]
    ds_read_b128 v[92:95], v15
    ds_read_b64_tr_b16 v[100:101], v17 offset:21504
    ds_read_b64_tr_b16 v[102:103], v17 offset:23296
    s_waitcnt lgkmcnt(9)
    v_mfma_f32_32x32x16_bf16 v[144:159], v[76:79], v[64:67], v[144:159]
    ds_read_b64_tr_b16 v[104:105], v18 offset:21504
    ds_read_b64_tr_b16 v[106:107], v18 offset:23296
    ds_read_b128 v[108:111], v23 offset:0
    v_add_u32 v11, 0xb000, v11
    v_add_u32 v15, 0xb000, v15
    v_mfma_f32_32x32x16_bf16 v[160:175], v[76:79], v[68:71], v[160:175]
    v_add_u32 v16, 0xb000, v16
    v_add_u32 v17, 0xb000, v17
    v_add_u32 v18, 0xb000, v18
    s_waitcnt lgkmcnt(10)
    v_mfma_f32_32x32x16_bf16 v[176:191], v[80:83], v[64:67], v[176:191]
    v_mfma_f32_32x32x16_bf16 v[192:207], v[80:83], v[68:71], v[192:207]
    s_waitcnt lgkmcnt(9)
    v_mfma_f32_32x32x16_bf16 v[208:223], v[76:79], v[84:87], v[208:223]
    s_waitcnt lgkmcnt(0)
    v_mfma_f32_32x32x16_bf16 v[112:127], v[96:99], v[88:91], v[112:127]
    s_barrier
    ds_read_b128 v[64:67], v8
    ds_read_b64_tr_b16 v[72:73], v16 offset:0
    ds_read_b64_tr_b16 v[74:75], v16 offset:1792
    v_mfma_f32_32x32x16_bf16 v[128:143], v[96:99], v[92:95], v[128:143]
    ds_read_b128 v[68:71], v12
    ds_read_b64_tr_b16 v[76:77], v17 offset:0
    ds_read_b64_tr_b16 v[78:79], v17 offset:1792
    v_mfma_f32_32x32x16_bf16 v[144:159], v[100:103], v[88:91], v[144:159]
    ds_read_b64_tr_b16 v[80:81], v18 offset:0
    ds_read_b64_tr_b16 v[82:83], v18 offset:1792
    ds_read_b128 v[84:87], v20 offset:2048
    v_add_u32 v8, 0xb000, v8
    v_add_u32 v12, 0xb000, v12
    v_mfma_f32_32x32x16_bf16 v[160:175], v[100:103], v[92:95], v[160:175]
    s_waitcnt vmcnt(0)
    v_lshlrev_b32 v228, 16, v224
    v_lshlrev_b32 v240, 16, v236
    v_and_b32 v229, 0xffff0000, v224
    v_and_b32 v241, 0xffff0000, v236
    v_mfma_f32_32x32x16_bf16 v[176:191], v[104:107], v[88:91], v[176:191]
    v_lshlrev_b32 v230, 16, v225
    v_lshlrev_b32 v242, 16, v237
    v_and_b32 v231, 0xffff0000, v225
    v_and_b32 v243, 0xffff0000, v237
    v_lshlrev_b32 v232, 16, v226
    v_mfma_f32_32x32x16_bf16 v[192:207], v[104:107], v[92:95], v[192:207]
    v_lshlrev_b32 v244, 16, v238
    v_and_b32 v233, 0xffff0000, v226
    v_and_b32 v245, 0xffff0000, v238
    v_lshlrev_b32 v234, 16, v227
    v_lshlrev_b32 v246, 16, v239
    v_mfma_f32_32x32x16_bf16 v[208:223], v[100:103], v[108:111], v[208:223]
    v_and_b32 v235, 0xffff0000, v227
    v_and_b32 v247, 0xffff0000, v239
    v_add_f32 v224, v228, v229
    v_add_f32 v236, v240, v241
    s_waitcnt lgkmcnt(6)
    v_mfma_f32_32x32x16_bf16 v[112:127], v[72:75], v[64:67], v[112:127]
    ds_read_b128 v[88:91], v9
    ds_read_b64_tr_b16 v[96:97], v16 offset:7168
    ds_read_b64_tr_b16 v[98:99], v16 offset:8960
    s_waitcnt lgkmcnt(8)
    v_mfma_f32_32x32x16_bf16 v[128:143], v[72:75], v[68:71], v[128:143]
    ds_read_b128 v[92:95], v13
    ds_read_b64_tr_b16 v[100:101], v17 offset:7168
    ds_read_b64_tr_b16 v[102:103], v17 offset:8960
    s_waitcnt lgkmcnt(9)
    v_mfma_f32_32x32x16_bf16 v[144:159], v[76:79], v[64:67], v[144:159]
    ds_read_b64_tr_b16 v[104:105], v18 offset:7168
    ds_read_b64_tr_b16 v[106:107], v18 offset:8960
    ds_read_b128 v[108:111], v21 offset:2048
    v_add_u32 v9, 0xb000, v9
    v_add_u32 v13, 0xb000, v13
    v_mfma_f32_32x32x16_bf16 v[160:175], v[76:79], v[68:71], v[160:175]
    v_add_f32 v225, v230, v231
    v_add_f32 v237, v242, v243
    v_add_f32 v226, v232, v233
    v_add_f32 v238, v244, v245
    v_add_f32 v227, v234, v235
    s_waitcnt lgkmcnt(10)
    v_mfma_f32_32x32x16_bf16 v[176:191], v[80:83], v[64:67], v[176:191]
    v_add_f32 v239, v246, v247
    v_add_f32 v224, v224, v225
    v_add_f32 v236, v236, v237
    v_add_f32 v226, v226, v227
    v_add_f32 v238, v238, v239
    v_mfma_f32_32x32x16_bf16 v[192:207], v[80:83], v[68:71], v[192:207]
    v_add_f32 v224, v224, v226
    v_add_f32 v236, v236, v238
    s_nop 0
    v_add_f32_dpp v224, v224, v224 row_shr:1 row_mask:0xf bank_mask:0xf bound_ctrl:0
    v_add_f32_dpp v236, v236, v236 row_shr:1 row_mask:0xf bank_mask:0xf bound_ctrl:0
    s_nop 0
    v_add_f32_dpp v224, v224, v224 row_shr:2 row_mask:0xf bank_mask:0xf bound_ctrl:0
    s_waitcnt lgkmcnt(9)
    v_mfma_f32_32x32x16_bf16 v[208:223], v[76:79], v[84:87], v[208:223]
    v_add_f32_dpp v236, v236, v236 row_shr:2 row_mask:0xf bank_mask:0xf bound_ctrl:0
    v_add_f32_dpp v224, v224, v224 row_shr:4 row_mask:0xf bank_mask:0xf bound_ctrl:0
    s_nop 0
    v_add_f32_dpp v236, v236, v236 row_shr:4 row_mask:0xf bank_mask:0xf bound_ctrl:0
    s_waitcnt lgkmcnt(6)
    v_mfma_f32_32x32x16_bf16 v[112:127], v[96:99], v[88:91], v[112:127]
    ds_read_b128 v[64:67], v10
    ds_read_b64_tr_b16 v[72:73], v16 offset:14336
    ds_read_b64_tr_b16 v[74:75], v16 offset:16128
    s_waitcnt lgkmcnt(8)
    v_mfma_f32_32x32x16_bf16 v[128:143], v[96:99], v[92:95], v[128:143]
    ds_read_b128 v[68:71], v14
    ds_read_b64_tr_b16 v[76:77], v17 offset:14336
    ds_read_b64_tr_b16 v[78:79], v17 offset:16128
    s_waitcnt lgkmcnt(9)
    v_mfma_f32_32x32x16_bf16 v[144:159], v[100:103], v[88:91], v[144:159]
    ds_read_b64_tr_b16 v[80:81], v18 offset:14336
    ds_read_b64_tr_b16 v[82:83], v18 offset:16128
    ds_read_b128 v[84:87], v22 offset:2048
    v_add_u32 v10, 0xb000, v10
    v_add_u32 v14, 0xb000, v14
    v_mfma_f32_32x32x16_bf16 v[160:175], v[100:103], v[92:95], v[160:175]
    v_add_f32_dpp v224, v224, v224 row_shr:8 row_mask:0xf bank_mask:0xf bound_ctrl:0
    v_add_f32_dpp v236, v236, v236 row_shr:8 row_mask:0xf bank_mask:0xf bound_ctrl:0
    s_nop 0
    v_add_f32_dpp v224, v224, v224 row_bcast:15 row_mask:0xa bank_mask:0xf
    v_add_f32_dpp v236, v236, v236 row_bcast:15 row_mask:0xa bank_mask:0xf
    s_nop 0
    v_add_f32_dpp v224, v224, v224 row_bcast:31 row_mask:0xc bank_mask:0xf
    s_waitcnt lgkmcnt(10)
    v_mfma_f32_32x32x16_bf16 v[176:191], v[104:107], v[88:91], v[176:191]
    v_add_f32_dpp v236, v236, v236 row_bcast:31 row_mask:0xc bank_mask:0xf
    v_readlane_b32 s69, v224, 63
    v_readlane_b32 s70, v236, 63
    v_mov_b32 v225, 0x3b000000
    v_mov_b32 v237, 0x3b000000
    v_mfma_f32_32x32x16_bf16 v[192:207], v[104:107], v[92:95], v[192:207]
    v_mul_f32 v226, s69, v225
    v_mul_f32 v238, s70, v237
    v_sub_f32 v228, v228, v226
    v_sub_f32 v240, v240, v238
    v_sub_f32 v229, v229, v226
    s_waitcnt lgkmcnt(9)
    v_mfma_f32_32x32x16_bf16 v[208:223], v[100:103], v[108:111], v[208:223]
    v_sub_f32 v241, v241, v238
    v_sub_f32 v230, v230, v226
    v_sub_f32 v242, v242, v238
    s_waitcnt lgkmcnt(6)
    v_mfma_f32_32x32x16_bf16 v[112:127], v[72:75], v[64:67], v[112:127]
    ds_read_b128 v[88:91], v11
    ds_read_b64_tr_b16 v[96:97], v16 offset:21504
    ds_read_b64_tr_b16 v[98:99], v16 offset:23296
    s_waitcnt lgkmcnt(8)
    v_mfma_f32_32x32x16_bf16 v[128:143], v[72:75], v[68:71], v[128:143]
    ds_read_b128 v[92:95], v15
    ds_read_b64_tr_b16 v[100:101], v17 offset:21504
    ds_read_b64_tr_b16 v[102:103], v17 offset:23296
    s_waitcnt lgkmcnt(9)
    v_mfma_f32_32x32x16_bf16 v[144:159], v[76:79], v[64:67], v[144:159]
    ds_read_b64_tr_b16 v[104:105], v18 offset:21504
    ds_read_b64_tr_b16 v[106:107], v18 offset:23296
    ds_read_b128 v[108:111], v23 offset:2048
    v_add_u32 v11, 0xb000, v11
    v_add_u32 v15, 0xb000, v15
    v_mfma_f32_32x32x16_bf16 v[160:175], v[76:79], v[68:71], v[160:175]
    v_add_u32 v16, 0xb000, v16
    v_add_u32 v17, 0xb000, v17
    v_add_u32 v18, 0xb000, v18
    v_sub_f32 v231, v231, v226
    v_sub_f32 v243, v243, v238
    s_waitcnt lgkmcnt(10)
    v_mfma_f32_32x32x16_bf16 v[176:191], v[80:83], v[64:67], v[176:191]
    v_sub_f32 v232, v232, v226
    v_sub_f32 v244, v244, v238
    v_sub_f32 v233, v233, v226
    v_sub_f32 v245, v245, v238
    v_sub_f32 v234, v234, v226
    v_mfma_f32_32x32x16_bf16 v[192:207], v[80:83], v[68:71], v[192:207]
    v_sub_f32 v246, v246, v238
    v_sub_f32 v235, v235, v226
    v_sub_f32 v247, v247, v238
    v_mul_f32 v224, v228, v228
    v_mul_f32 v236, v240, v240
    s_waitcnt lgkmcnt(9)
    v_mfma_f32_32x32x16_bf16 v[208:223], v[76:79], v[84:87], v[208:223]
    v_mul_f32 v227, v229, v229
    v_mul_f32 v239, v241, v241
    v_fmac_f32 v224, v230, v230
    v_fmac_f32 v236, v242, v242
    v_fmac_f32 v227, v231, v231
    v_fmac_f32 v239, v243, v243
    s_waitcnt lgkmcnt(0)
    v_mfma_f32_32x32x16_bf16 v[112:127], v[96:99], v[88:91], v[112:127]
    s_barrier
    ds_read_b128 v[64:67], v8
    ds_read_b64_tr_b16 v[72:73], v16 offset:0
    ds_read_b64_tr_b16 v[74:75], v16 offset:1792
    v_mfma_f32_32x32x16_bf16 v[128:143], v[96:99], v[92:95], v[128:143]
    ds_read_b128 v[68:71], v12
    ds_read_b64_tr_b16 v[76:77], v17 offset:0
    ds_read_b64_tr_b16 v[78:79], v17 offset:1792
    v_mfma_f32_32x32x16_bf16 v[144:159], v[100:103], v[88:91], v[144:159]
    ds_read_b64_tr_b16 v[80:81], v18 offset:0
    ds_read_b64_tr_b16 v[82:83], v18 offset:1792
    ds_read_b128 v[84:87], v20 offset:4096
    v_add_u32 v8, 0xfffea000, v8
    v_add_u32 v12, 0xfffea000, v12
    v_mfma_f32_32x32x16_bf16 v[160:175], v[100:103], v[92:95], v[160:175]
    v_fmac_f32 v224, v232, v232
    v_fmac_f32 v236, v244, v244
    v_fmac_f32 v227, v233, v233
    v_fmac_f32 v239, v245, v245
    v_fmac_f32 v224, v234, v234
    v_mfma_f32_32x32x16_bf16 v[176:191], v[104:107], v[88:91], v[176:191]
    v_fmac_f32 v236, v246, v246
    v_fmac_f32 v227, v235, v235
    v_fmac_f32 v239, v247, v247
    v_add_f32 v224, v224, v227
    v_add_f32 v236, v236, v239
    v_mfma_f32_32x32x16_bf16 v[192:207], v[104:107], v[92:95], v[192:207]
    v_add_f32_dpp v224, v224, v224 row_shr:1 row_mask:0xf bank_mask:0xf bound_ctrl:0
    v_add_f32_dpp v236, v236, v236 row_shr:1 row_mask:0xf bank_mask:0xf bound_ctrl:0
    s_nop 0
    v_add_f32_dpp v224, v224, v224 row_shr:2 row_mask:0xf bank_mask:0xf bound_ctrl:0
    v_add_f32_dpp v236, v236, v236 row_shr:2 row_mask:0xf bank_mask:0xf bound_ctrl:0
    s_nop 0
    v_add_f32_dpp v224, v224, v224 row_shr:4 row_mask:0xf bank_mask:0xf bound_ctrl:0
    v_mfma_f32_32x32x16_bf16 v[208:223], v[100:103], v[108:111], v[208:223]
    v_add_f32_dpp v236, v236, v236 row_shr:4 row_mask:0xf bank_mask:0xf bound_ctrl:0
    v_add_f32_dpp v224, v224, v224 row_shr:8 row_mask:0xf bank_mask:0xf bound_ctrl:0
    s_nop 0
    v_add_f32_dpp v236, v236, v236 row_shr:8 row_mask:0xf bank_mask:0xf bound_ctrl:0
    s_waitcnt lgkmcnt(6)
    v_mfma_f32_32x32x16_bf16 v[112:127], v[72:75], v[64:67], v[112:127]
    ds_read_b128 v[88:91], v9
    ds_read_b64_tr_b16 v[96:97], v16 offset:7168
    ds_read_b64_tr_b16 v[98:99], v16 offset:8960
    s_waitcnt lgkmcnt(8)
    v_mfma_f32_32x32x16_bf16 v[128:143], v[72:75], v[68:71], v[128:143]
    ds_read_b128 v[92:95], v13
    ds_read_b64_tr_b16 v[100:101], v17 offset:7168
    ds_read_b64_tr_b16 v[102:103], v17 offset:8960
    s_waitcnt lgkmcnt(9)
    v_mfma_f32_32x32x16_bf16 v[144:159], v[76:79], v[64:67], v[144:159]
    ds_read_b64_tr_b16 v[104:105], v18 offset:7168
    ds_read_b64_tr_b16 v[106:107], v18 offset:8960
    ds_read_b128 v[108:111], v21 offset:4096
    v_add_u32 v9, 0xfffea000, v9
    v_add_u32 v13, 0xfffea000, v13
    v_mfma_f32_32x32x16_bf16 v[160:175], v[76:79], v[68:71], v[160:175]
    v_add_f32_dpp v224, v224, v224 row_bcast:15 row_mask:0xa bank_mask:0xf
    v_add_f32_dpp v236, v236, v236 row_bcast:15 row_mask:0xa bank_mask:0xf
    s_nop 0
    v_add_f32_dpp v224, v224, v224 row_bcast:31 row_mask:0xc bank_mask:0xf
    v_add_f32_dpp v236, v236, v236 row_bcast:31 row_mask:0xc bank_mask:0xf
    v_readlane_b32 s69, v224, 63
    s_waitcnt lgkmcnt(10)
    v_mfma_f32_32x32x16_bf16 v[176:191], v[80:83], v[64:67], v[176:191]
    v_readlane_b32 s70, v236, 63
    v_mul_f32 v224, s69, v225
    s_nop 0
    v_mul_f32 v236, s70, v237
    v_cvt_pk_bf16_f32 v224, v224, v224
    v_cvt_pk_bf16_f32 v236, v236, v236
    v_mfma_f32_32x32x16_bf16 v[192:207], v[80:83], v[68:71], v[192:207]
    v_and_b32 v224, 0xffff0000, v224
    v_and_b32 v236, 0xffff0000, v236
    v_add_f32 v224, 0x3727c5ac, v224
    v_add_f32 v236, 0x3727c5ac, v236
    v_cvt_pk_bf16_f32 v224, v224, v224
    s_waitcnt lgkmcnt(9)
    v_mfma_f32_32x32x16_bf16 v[208:223], v[76:79], v[84:87], v[208:223]
    v_cvt_pk_bf16_f32 v236, v236, v236
    v_and_b32 v224, 0xffff0000, v224
    v_and_b32 v236, 0xffff0000, v236
    s_waitcnt lgkmcnt(6)
    v_mfma_f32_32x32x16_bf16 v[112:127], v[96:99], v[88:91], v[112:127]
    ds_read_b128 v[64:67], v10
    ds_read_b64_tr_b16 v[72:73], v16 offset:14336
    ds_read_b64_tr_b16 v[74:75], v16 offset:16128
    s_waitcnt lgkmcnt(8)
    v_mfma_f32_32x32x16_bf16 v[128:143], v[96:99], v[92:95], v[128:143]
    ds_read_b128 v[68:71], v14
    ds_read_b64_tr_b16 v[76:77], v17 offset:14336
    ds_read_b64_tr_b16 v[78:79], v17 offset:16128
    s_waitcnt lgkmcnt(9)
    v_mfma_f32_32x32x16_bf16 v[144:159], v[100:103], v[88:91], v[144:159]
    ds_read_b64_tr_b16 v[80:81], v18 offset:14336
    ds_read_b64_tr_b16 v[82:83], v18 offset:16128
    ds_read_b128 v[84:87], v22 offset:4096
    v_add_u32 v10, 0xfffea000, v10
    v_add_u32 v14, 0xfffea000, v14
    v_mfma_f32_32x32x16_bf16 v[160:175], v[100:103], v[92:95], v[160:175]
    v_sqrt_f32 v224, v224
    v_sqrt_f32 v236, v236
    v_cvt_pk_bf16_f32 v224, v226, v224
    v_cvt_pk_bf16_f32 v236, v238, v236
    v_mov_b32 v225, v236
    s_waitcnt lgkmcnt(10)
    v_mfma_f32_32x32x16_bf16 v[176:191], v[104:107], v[88:91], v[176:191]
    ds_write_b64 v5, v[224:225] offset:31744
    v_mfma_f32_32x32x16_bf16 v[192:207], v[104:107], v[92:95], v[192:207]
    s_waitcnt lgkmcnt(10)
    v_mfma_f32_32x32x16_bf16 v[208:223], v[100:103], v[108:111], v[208:223]
    s_waitcnt lgkmcnt(7)
    v_mfma_f32_32x32x16_bf16 v[112:127], v[72:75], v[64:67], v[112:127]
    ds_read_b128 v[88:91], v11
    ds_read_b64_tr_b16 v[96:97], v16 offset:21504
    ds_read_b64_tr_b16 v[98:99], v16 offset:23296
    s_waitcnt lgkmcnt(9)
    v_mfma_f32_32x32x16_bf16 v[128:143], v[72:75], v[68:71], v[128:143]
    ds_read_b128 v[92:95], v15
    ds_read_b64_tr_b16 v[100:101], v17 offset:21504
    ds_read_b64_tr_b16 v[102:103], v17 offset:23296
    s_waitcnt lgkmcnt(10)
    v_mfma_f32_32x32x16_bf16 v[144:159], v[76:79], v[64:67], v[144:159]
    ds_read_b64_tr_b16 v[104:105], v18 offset:21504
    ds_read_b64_tr_b16 v[106:107], v18 offset:23296
    ds_read_b128 v[108:111], v23 offset:4096
    v_add_u32 v11, 0xfffea000, v11
    v_add_u32 v15, 0xfffea000, v15
    v_mfma_f32_32x32x16_bf16 v[160:175], v[76:79], v[68:71], v[160:175]
    v_add_u32 v16, 0xfffea000, v16
    v_add_u32 v17, 0xfffea000, v17
    v_add_u32 v18, 0xfffea000, v18
    s_waitcnt lgkmcnt(11)
    v_mfma_f32_32x32x16_bf16 v[176:191], v[80:83], v[64:67], v[176:191]
    v_mfma_f32_32x32x16_bf16 v[192:207], v[80:83], v[68:71], v[192:207]
    s_waitcnt lgkmcnt(10)
    v_mfma_f32_32x32x16_bf16 v[208:223], v[76:79], v[84:87], v[208:223]
    s_waitcnt lgkmcnt(0)
    v_mfma_f32_32x32x16_bf16 v[112:127], v[96:99], v[88:91], v[112:127]
    s_barrier
    ds_read_b128 v[64:67], v8
    ds_read_b64_tr_b16 v[72:73], v16 offset:0
    ds_read_b64_tr_b16 v[74:75], v16 offset:1792
    v_mfma_f32_32x32x16_bf16 v[128:143], v[96:99], v[92:95], v[128:143]
    ds_read_b128 v[68:71], v12
    ds_read_b64_tr_b16 v[76:77], v17 offset:0
    ds_read_b64_tr_b16 v[78:79], v17 offset:1792
    v_mfma_f32_32x32x16_bf16 v[144:159], v[100:103], v[88:91], v[144:159]
    ds_read_b64_tr_b16 v[80:81], v18 offset:0
    ds_read_b64_tr_b16 v[82:83], v18 offset:1792
    ds_read_b128 v[84:87], v20 offset:6144
    v_add_u32 v8, 0xb000, v8
    v_add_u32 v12, 0xb000, v12
    v_mfma_f32_32x32x16_bf16 v[160:175], v[100:103], v[92:95], v[160:175]
    v_mfma_f32_32x32x16_bf16 v[176:191], v[104:107], v[88:91], v[176:191]
    v_mfma_f32_32x32x16_bf16 v[192:207], v[104:107], v[92:95], v[192:207]
    v_mfma_f32_32x32x16_bf16 v[208:223], v[100:103], v[108:111], v[208:223]
    s_waitcnt lgkmcnt(6)
    v_mfma_f32_32x32x16_bf16 v[112:127], v[72:75], v[64:67], v[112:127]
    ds_read_b128 v[88:91], v9
    ds_read_b64_tr_b16 v[96:97], v16 offset:7168
    ds_read_b64_tr_b16 v[98:99], v16 offset:8960
    s_waitcnt lgkmcnt(8)
    v_mfma_f32_32x32x16_bf16 v[128:143], v[72:75], v[68:71], v[128:143]
    ds_read_b128 v[92:95], v13
    ds_read_b64_tr_b16 v[100:101], v17 offset:7168
    ds_read_b64_tr_b16 v[102:103], v17 offset:8960
    s_waitcnt lgkmcnt(9)
    v_mfma_f32_32x32x16_bf16 v[144:159], v[76:79], v[64:67], v[144:159]
    ds_read_b64_tr_b16 v[104:105], v18 offset:7168
    ds_read_b64_tr_b16 v[106:107], v18 offset:8960
    ds_read_b128 v[108:111], v21 offset:6144
    v_add_u32 v9, 0xb000, v9
    v_add_u32 v13, 0xb000, v13
    v_mfma_f32_32x32x16_bf16 v[160:175], v[76:79], v[68:71], v[160:175]
    s_waitcnt lgkmcnt(10)
    v_mfma_f32_32x32x16_bf16 v[176:191], v[80:83], v[64:67], v[176:191]
    v_mfma_f32_32x32x16_bf16 v[192:207], v[80:83], v[68:71], v[192:207]
    s_waitcnt lgkmcnt(9)
    v_mfma_f32_32x32x16_bf16 v[208:223], v[76:79], v[84:87], v[208:223]
    s_waitcnt lgkmcnt(6)
    v_mfma_f32_32x32x16_bf16 v[112:127], v[96:99], v[88:91], v[112:127]
    ds_read_b128 v[64:67], v10
    ds_read_b64_tr_b16 v[72:73], v16 offset:14336
    ds_read_b64_tr_b16 v[74:75], v16 offset:16128
    s_waitcnt lgkmcnt(8)
    v_mfma_f32_32x32x16_bf16 v[128:143], v[96:99], v[92:95], v[128:143]
    ds_read_b128 v[68:71], v14
    ds_read_b64_tr_b16 v[76:77], v17 offset:14336
    ds_read_b64_tr_b16 v[78:79], v17 offset:16128
    s_waitcnt lgkmcnt(9)
    v_mfma_f32_32x32x16_bf16 v[144:159], v[100:103], v[88:91], v[144:159]
    ds_read_b64_tr_b16 v[80:81], v18 offset:14336
    ds_read_b64_tr_b16 v[82:83], v18 offset:16128
    ds_read_b128 v[84:87], v22 offset:6144
    v_add_u32 v10, 0xb000, v10
    v_add_u32 v14, 0xb000, v14
    v_mfma_f32_32x32x16_bf16 v[160:175], v[100:103], v[92:95], v[160:175]
    s_waitcnt lgkmcnt(10)
    v_mfma_f32_32x32x16_bf16 v[176:191], v[104:107], v[88:91], v[176:191]
    v_mfma_f32_32x32x16_bf16 v[192:207], v[104:107], v[92:95], v[192:207]
    s_waitcnt lgkmcnt(9)
    v_mfma_f32_32x32x16_bf16 v[208:223], v[100:103], v[108:111], v[208:223]
    s_waitcnt lgkmcnt(6)
    v_mfma_f32_32x32x16_bf16 v[112:127], v[72:75], v[64:67], v[112:127]
    ds_read_b128 v[88:91], v11
    ds_read_b64_tr_b16 v[96:97], v16 offset:21504
    ds_read_b64_tr_b16 v[98:99], v16 offset:23296
    s_waitcnt lgkmcnt(8)
    v_mfma_f32_32x32x16_bf16 v[128:143], v[72:75], v[68:71], v[128:143]
    ds_read_b128 v[92:95], v15
    ds_read_b64_tr_b16 v[100:101], v17 offset:21504
    ds_read_b64_tr_b16 v[102:103], v17 offset:23296
    s_waitcnt lgkmcnt(9)
    v_mfma_f32_32x32x16_bf16 v[144:159], v[76:79], v[64:67], v[144:159]
    ds_read_b64_tr_b16 v[104:105], v18 offset:21504
    ds_read_b64_tr_b16 v[106:107], v18 offset:23296
    ds_read_b128 v[108:111], v23 offset:6144
    v_add_u32 v11, 0xb000, v11
    v_add_u32 v15, 0xb000, v15
    v_mfma_f32_32x32x16_bf16 v[160:175], v[76:79], v[68:71], v[160:175]
    v_add_u32 v16, 0xb000, v16
    v_add_u32 v17, 0xb000, v17
    v_add_u32 v18, 0xb000, v18
    s_waitcnt lgkmcnt(10)
    v_mfma_f32_32x32x16_bf16 v[176:191], v[80:83], v[64:67], v[176:191]
    v_mfma_f32_32x32x16_bf16 v[192:207], v[80:83], v[68:71], v[192:207]
    s_waitcnt lgkmcnt(9)
    v_mfma_f32_32x32x16_bf16 v[208:223], v[76:79], v[84:87], v[208:223]
    s_waitcnt lgkmcnt(0)
    v_mfma_f32_32x32x16_bf16 v[112:127], v[96:99], v[88:91], v[112:127]
    s_barrier
    ds_read_b128 v[64:67], v8
    ds_read_b64_tr_b16 v[72:73], v16 offset:0
    ds_read_b64_tr_b16 v[74:75], v16 offset:1792
    v_mfma_f32_32x32x16_bf16 v[128:143], v[96:99], v[92:95], v[128:143]
    ds_read_b128 v[68:71], v12
    ds_read_b64_tr_b16 v[76:77], v17 offset:0
    ds_read_b64_tr_b16 v[78:79], v17 offset:1792
    v_mfma_f32_32x32x16_bf16 v[144:159], v[100:103], v[88:91], v[144:159]
    ds_read_b64_tr_b16 v[80:81], v18 offset:0
    ds_read_b64_tr_b16 v[82:83], v18 offset:1792
    ds_read_b128 v[84:87], v20 offset:8192
    v_add_u32 v8, 0xb000, v8
    v_add_u32 v12, 0xb000, v12
    v_mfma_f32_32x32x16_bf16 v[160:175], v[100:103], v[92:95], v[160:175]
    v_mfma_f32_32x32x16_bf16 v[176:191], v[104:107], v[88:91], v[176:191]
    v_mfma_f32_32x32x16_bf16 v[192:207], v[104:107], v[92:95], v[192:207]
    v_mfma_f32_32x32x16_bf16 v[208:223], v[100:103], v[108:111], v[208:223]
    s_waitcnt lgkmcnt(6)
    v_mfma_f32_32x32x16_bf16 v[112:127], v[72:75], v[64:67], v[112:127]
    ds_read_b128 v[88:91], v9
    ds_read_b64_tr_b16 v[96:97], v16 offset:7168
    ds_read_b64_tr_b16 v[98:99], v16 offset:8960
    s_waitcnt lgkmcnt(8)
    v_mfma_f32_32x32x16_bf16 v[128:143], v[72:75], v[68:71], v[128:143]
    ds_read_b128 v[92:95], v13
    ds_read_b64_tr_b16 v[100:101], v17 offset:7168
    ds_read_b64_tr_b16 v[102:103], v17 offset:8960
    s_waitcnt lgkmcnt(9)
    v_mfma_f32_32x32x16_bf16 v[144:159], v[76:79], v[64:67], v[144:159]
    ds_read_b64_tr_b16 v[104:105], v18 offset:7168
    ds_read_b64_tr_b16 v[106:107], v18 offset:8960
    ds_read_b128 v[108:111], v21 offset:8192
    v_add_u32 v9, 0xb000, v9
    v_add_u32 v13, 0xb000, v13
    v_mfma_f32_32x32x16_bf16 v[160:175], v[76:79], v[68:71], v[160:175]
    s_waitcnt lgkmcnt(10)
    v_mfma_f32_32x32x16_bf16 v[176:191], v[80:83], v[64:67], v[176:191]
    v_mfma_f32_32x32x16_bf16 v[192:207], v[80:83], v[68:71], v[192:207]
    s_waitcnt lgkmcnt(9)
    v_mfma_f32_32x32x16_bf16 v[208:223], v[76:79], v[84:87], v[208:223]
    s_waitcnt lgkmcnt(6)
    v_mfma_f32_32x32x16_bf16 v[112:127], v[96:99], v[88:91], v[112:127]
    ds_read_b128 v[64:67], v10
    ds_read_b64_tr_b16 v[72:73], v16 offset:14336
    ds_read_b64_tr_b16 v[74:75], v16 offset:16128
    s_waitcnt lgkmcnt(8)
    v_mfma_f32_32x32x16_bf16 v[128:143], v[96:99], v[92:95], v[128:143]
    ds_read_b128 v[68:71], v14
    ds_read_b64_tr_b16 v[76:77], v17 offset:14336
    ds_read_b64_tr_b16 v[78:79], v17 offset:16128
    s_waitcnt lgkmcnt(9)
    v_mfma_f32_32x32x16_bf16 v[144:159], v[100:103], v[88:91], v[144:159]
    ds_read_b64_tr_b16 v[80:81], v18 offset:14336
    ds_read_b64_tr_b16 v[82:83], v18 offset:16128
    ds_read_b128 v[84:87], v22 offset:8192
    v_add_u32 v10, 0xb000, v10
    v_add_u32 v14, 0xb000, v14
    v_mfma_f32_32x32x16_bf16 v[160:175], v[100:103], v[92:95], v[160:175]
    s_waitcnt lgkmcnt(10)
    v_mfma_f32_32x32x16_bf16 v[176:191], v[104:107], v[88:91], v[176:191]
    v_mfma_f32_32x32x16_bf16 v[192:207], v[104:107], v[92:95], v[192:207]
    s_waitcnt lgkmcnt(9)
    v_mfma_f32_32x32x16_bf16 v[208:223], v[100:103], v[108:111], v[208:223]
    s_waitcnt lgkmcnt(6)
    v_mfma_f32_32x32x16_bf16 v[112:127], v[72:75], v[64:67], v[112:127]
    ds_read_b128 v[88:91], v11
    ds_read_b64_tr_b16 v[96:97], v16 offset:21504
    ds_read_b64_tr_b16 v[98:99], v16 offset:23296
    s_waitcnt lgkmcnt(8)
    v_mfma_f32_32x32x16_bf16 v[128:143], v[72:75], v[68:71], v[128:143]
    ds_read_b128 v[92:95], v15
    ds_read_b64_tr_b16 v[100:101], v17 offset:21504
    ds_read_b64_tr_b16 v[102:103], v17 offset:23296
    s_waitcnt lgkmcnt(9)
    v_mfma_f32_32x32x16_bf16 v[144:159], v[76:79], v[64:67], v[144:159]
    ds_read_b64_tr_b16 v[104:105], v18 offset:21504
    ds_read_b64_tr_b16 v[106:107], v18 offset:23296
    ds_read_b128 v[108:111], v23 offset:8192
    v_add_u32 v11, 0xb000, v11
    v_add_u32 v15, 0xb000, v15
    v_mfma_f32_32x32x16_bf16 v[160:175], v[76:79], v[68:71], v[160:175]
    v_add_u32 v16, 0xb000, v16
    v_add_u32 v17, 0xb000, v17
    v_add_u32 v18, 0xb000, v18
    s_waitcnt lgkmcnt(10)
    v_mfma_f32_32x32x16_bf16 v[176:191], v[80:83], v[64:67], v[176:191]
    v_mfma_f32_32x32x16_bf16 v[192:207], v[80:83], v[68:71], v[192:207]
    s_waitcnt lgkmcnt(9)
    v_mfma_f32_32x32x16_bf16 v[208:223], v[76:79], v[84:87], v[208:223]
    s_waitcnt lgkmcnt(0)
    v_mfma_f32_32x32x16_bf16 v[112:127], v[96:99], v[88:91], v[112:127]
    s_barrier
    ds_read_b128 v[64:67], v8
    ds_read_b64_tr_b16 v[72:73], v16 offset:0
    ds_read_b64_tr_b16 v[74:75], v16 offset:1792
    v_mfma_f32_32x32x16_bf16 v[128:143], v[96:99], v[92:95], v[128:143]
    ds_read_b128 v[68:71], v12
    ds_read_b64_tr_b16 v[76:77], v17 offset:0
    ds_read_b64_tr_b16 v[78:79], v17 offset:1792
    v_mfma_f32_32x32x16_bf16 v[144:159], v[100:103], v[88:91], v[144:159]
    ds_read_b64_tr_b16 v[80:81], v18 offset:0
    ds_read_b64_tr_b16 v[82:83], v18 offset:1792
    ds_read_b128 v[84:87], v20 offset:10240
    v_add_u32 v8, 0xfffea000, v8
    v_add_u32 v12, 0xfffea000, v12
    v_mfma_f32_32x32x16_bf16 v[160:175], v[100:103], v[92:95], v[160:175]
    v_mfma_f32_32x32x16_bf16 v[176:191], v[104:107], v[88:91], v[176:191]
    v_mfma_f32_32x32x16_bf16 v[192:207], v[104:107], v[92:95], v[192:207]
    v_mfma_f32_32x32x16_bf16 v[208:223], v[100:103], v[108:111], v[208:223]
    s_waitcnt lgkmcnt(6)
    v_mfma_f32_32x32x16_bf16 v[112:127], v[72:75], v[64:67], v[112:127]
    ds_read_b128 v[88:91], v9
    ds_read_b64_tr_b16 v[96:97], v16 offset:7168
    ds_read_b64_tr_b16 v[98:99], v16 offset:8960
    s_waitcnt lgkmcnt(8)
    v_mfma_f32_32x32x16_bf16 v[128:143], v[72:75], v[68:71], v[128:143]
    ds_read_b128 v[92:95], v13
    ds_read_b64_tr_b16 v[100:101], v17 offset:7168
    ds_read_b64_tr_b16 v[102:103], v17 offset:8960
    s_waitcnt lgkmcnt(9)
    v_mfma_f32_32x32x16_bf16 v[144:159], v[76:79], v[64:67], v[144:159]
    ds_read_b64_tr_b16 v[104:105], v18 offset:7168
    ds_read_b64_tr_b16 v[106:107], v18 offset:8960
    ds_read_b128 v[108:111], v21 offset:10240
    v_add_u32 v9, 0xfffea000, v9
    v_add_u32 v13, 0xfffea000, v13
    v_mfma_f32_32x32x16_bf16 v[160:175], v[76:79], v[68:71], v[160:175]
    s_waitcnt lgkmcnt(10)
    v_mfma_f32_32x32x16_bf16 v[176:191], v[80:83], v[64:67], v[176:191]
    v_mfma_f32_32x32x16_bf16 v[192:207], v[80:83], v[68:71], v[192:207]
    s_waitcnt lgkmcnt(9)
    v_mfma_f32_32x32x16_bf16 v[208:223], v[76:79], v[84:87], v[208:223]
    s_waitcnt lgkmcnt(6)
    v_mfma_f32_32x32x16_bf16 v[112:127], v[96:99], v[88:91], v[112:127]
    ds_read_b128 v[64:67], v10
    ds_read_b64_tr_b16 v[72:73], v16 offset:14336
    ds_read_b64_tr_b16 v[74:75], v16 offset:16128
    s_waitcnt lgkmcnt(8)
    v_mfma_f32_32x32x16_bf16 v[128:143], v[96:99], v[92:95], v[128:143]
    ds_read_b128 v[68:71], v14
    ds_read_b64_tr_b16 v[76:77], v17 offset:14336
    ds_read_b64_tr_b16 v[78:79], v17 offset:16128
    s_waitcnt lgkmcnt(9)
    v_mfma_f32_32x32x16_bf16 v[144:159], v[100:103], v[88:91], v[144:159]
    ds_read_b64_tr_b16 v[80:81], v18 offset:14336
    ds_read_b64_tr_b16 v[82:83], v18 offset:16128
    ds_read_b128 v[84:87], v22 offset:10240
    v_add_u32 v10, 0xfffea000, v10
    v_add_u32 v14, 0xfffea000, v14
    v_mfma_f32_32x32x16_bf16 v[160:175], v[100:103], v[92:95], v[160:175]
    s_waitcnt lgkmcnt(10)
    v_mfma_f32_32x32x16_bf16 v[176:191], v[104:107], v[88:91], v[176:191]
    v_mfma_f32_32x32x16_bf16 v[192:207], v[104:107], v[92:95], v[192:207]
    s_waitcnt lgkmcnt(9)
    v_mfma_f32_32x32x16_bf16 v[208:223], v[100:103], v[108:111], v[208:223]
    s_waitcnt lgkmcnt(6)
    v_mfma_f32_32x32x16_bf16 v[112:127], v[72:75], v[64:67], v[112:127]
    ds_read_b128 v[88:91], v11
    ds_read_b64_tr_b16 v[96:97], v16 offset:21504
    ds_read_b64_tr_b16 v[98:99], v16 offset:23296
    s_waitcnt lgkmcnt(8)
    v_mfma_f32_32x32x16_bf16 v[128:143], v[72:75], v[68:71], v[128:143]
    ds_read_b128 v[92:95], v15
    ds_read_b64_tr_b16 v[100:101], v17 offset:21504
    ds_read_b64_tr_b16 v[102:103], v17 offset:23296
    s_waitcnt lgkmcnt(9)
    v_mfma_f32_32x32x16_bf16 v[144:159], v[76:79], v[64:67], v[144:159]
    ds_read_b64_tr_b16 v[104:105], v18 offset:21504
    ds_read_b64_tr_b16 v[106:107], v18 offset:23296
    ds_read_b128 v[108:111], v23 offset:10240
    v_add_u32 v11, 0xfffea000, v11
    v_add_u32 v15, 0xfffea000, v15
    v_mfma_f32_32x32x16_bf16 v[160:175], v[76:79], v[68:71], v[160:175]
    v_add_u32 v16, 0xfffea000, v16
    v_add_u32 v17, 0xfffea000, v17
    v_add_u32 v18, 0xfffea000, v18
    s_waitcnt lgkmcnt(10)
    v_mfma_f32_32x32x16_bf16 v[176:191], v[80:83], v[64:67], v[176:191]
    v_mfma_f32_32x32x16_bf16 v[192:207], v[80:83], v[68:71], v[192:207]
    s_waitcnt lgkmcnt(9)
    v_mfma_f32_32x32x16_bf16 v[208:223], v[76:79], v[84:87], v[208:223]
    s_waitcnt lgkmcnt(0)
    v_mfma_f32_32x32x16_bf16 v[112:127], v[96:99], v[88:91], v[112:127]
    s_barrier
    ds_read_b128 v[64:67], v8
    ds_read_b64_tr_b16 v[72:73], v16 offset:0
    ds_read_b64_tr_b16 v[74:75], v16 offset:1792
    v_mfma_f32_32x32x16_bf16 v[128:143], v[96:99], v[92:95], v[128:143]
    ds_read_b128 v[68:71], v12
    ds_read_b64_tr_b16 v[76:77], v17 offset:0
    ds_read_b64_tr_b16 v[78:79], v17 offset:1792
    v_mfma_f32_32x32x16_bf16 v[144:159], v[100:103], v[88:91], v[144:159]
    ds_read_b64_tr_b16 v[80:81], v18 offset:0
    ds_read_b64_tr_b16 v[82:83], v18 offset:1792
    ds_read_b128 v[84:87], v20 offset:12288
    v_add_u32 v8, 0xb000, v8
    v_add_u32 v12, 0xb000, v12
    v_mfma_f32_32x32x16_bf16 v[160:175], v[100:103], v[92:95], v[160:175]
    v_mfma_f32_32x32x16_bf16 v[176:191], v[104:107], v[88:91], v[176:191]
    v_mfma_f32_32x32x16_bf16 v[192:207], v[104:107], v[92:95], v[192:207]
    v_mfma_f32_32x32x16_bf16 v[208:223], v[100:103], v[108:111], v[208:223]
    s_waitcnt lgkmcnt(6)
    v_mfma_f32_32x32x16_bf16 v[112:127], v[72:75], v[64:67], v[112:127]
    ds_read_b128 v[88:91], v9
    ds_read_b64_tr_b16 v[96:97], v16 offset:7168
    ds_read_b64_tr_b16 v[98:99], v16 offset:8960
    s_waitcnt lgkmcnt(8)
    v_mfma_f32_32x32x16_bf16 v[128:143], v[72:75], v[68:71], v[128:143]
    ds_read_b128 v[92:95], v13
    ds_read_b64_tr_b16 v[100:101], v17 offset:7168
    ds_read_b64_tr_b16 v[102:103], v17 offset:8960
    s_waitcnt lgkmcnt(9)
    v_mfma_f32_32x32x16_bf16 v[144:159], v[76:79], v[64:67], v[144:159]
    ds_read_b64_tr_b16 v[104:105], v18 offset:7168
    ds_read_b64_tr_b16 v[106:107], v18 offset:8960
    ds_read_b128 v[108:111], v21 offset:12288
    v_add_u32 v9, 0xb000, v9
    v_add_u32 v13, 0xb000, v13
    v_mfma_f32_32x32x16_bf16 v[160:175], v[76:79], v[68:71], v[160:175]
    v_and_b32 v48, 31, v1
    s_lshl_b32 s67, s55, 7
    s_add_u32 s67, s67, 131072
    v_lshl_add_u32 v48, v48, 2, s67
    v_xor_b32 v54, 0x80, v48
    v_and_b32 v55, 15, v1
    s_waitcnt lgkmcnt(10)
    v_mfma_f32_32x32x16_bf16 v[176:191], v[80:83], v[64:67], v[176:191]
    v_lshl_add_u32 v55, v55, 2, v2
    v_mfma_f32_32x32x16_bf16 v[192:207], v[80:83], v[68:71], v[192:207]
    s_waitcnt lgkmcnt(9)
    v_mfma_f32_32x32x16_bf16 v[208:223], v[76:79], v[84:87], v[208:223]
    s_waitcnt lgkmcnt(6)
    v_mfma_f32_32x32x16_bf16 v[112:127], v[96:99], v[88:91], v[112:127]
    ds_read_b128 v[64:67], v10
    ds_read_b64_tr_b16 v[72:73], v16 offset:14336
    ds_read_b64_tr_b16 v[74:75], v16 offset:16128
    s_waitcnt lgkmcnt(8)
    v_mfma_f32_32x32x16_bf16 v[128:143], v[96:99], v[92:95], v[128:143]
    ds_read_b128 v[68:71], v14
    ds_read_b64_tr_b16 v[76:77], v17 offset:14336
    ds_read_b64_tr_b16 v[78:79], v17 offset:16128
    s_waitcnt lgkmcnt(9)
    v_mfma_f32_32x32x16_bf16 v[144:159], v[100:103], v[88:91], v[144:159]
    ds_read_b64_tr_b16 v[80:81], v18 offset:14336
    ds_read_b64_tr_b16 v[82:83], v18 offset:16128
    ds_read_b128 v[84:87], v22 offset:12288
    v_add_u32 v10, 0xb000, v10
    v_add_u32 v14, 0xb000, v14
    v_mfma_f32_32x32x16_bf16 v[160:175], v[100:103], v[92:95], v[160:175]
    s_waitcnt lgkmcnt(10)
    v_mfma_f32_32x32x16_bf16 v[176:191], v[104:107], v[88:91], v[176:191]
    v_mfma_f32_32x32x16_bf16 v[192:207], v[104:107], v[92:95], v[192:207]
    s_waitcnt lgkmcnt(9)
    v_mfma_f32_32x32x16_bf16 v[208:223], v[100:103], v[108:111], v[208:223]
    s_waitcnt lgkmcnt(6)
    v_mfma_f32_32x32x16_bf16 v[112:127], v[72:75], v[64:67], v[112:127]
    ds_read_b128 v[88:91], v11
    ds_read_b64_tr_b16 v[96:97], v16 offset:21504
    ds_read_b64_tr_b16 v[98:99], v16 offset:23296
    s_waitcnt lgkmcnt(8)
    v_mfma_f32_32x32x16_bf16 v[128:143], v[72:75], v[68:71], v[128:143]
    ds_read_b128 v[92:95], v15
    ds_read_b64_tr_b16 v[100:101], v17 offset:21504
    ds_read_b64_tr_b16 v[102:103], v17 offset:23296
    s_waitcnt lgkmcnt(9)
    v_mfma_f32_32x32x16_bf16 v[144:159], v[76:79], v[64:67], v[144:159]
    ds_read_b64_tr_b16 v[104:105], v18 offset:21504
    ds_read_b64_tr_b16 v[106:107], v18 offset:23296
    ds_read_b128 v[108:111], v23 offset:12288
    v_add_u32 v11, 0xb000, v11
    v_add_u32 v15, 0xb000, v15
    v_mfma_f32_32x32x16_bf16 v[160:175], v[76:79], v[68:71], v[160:175]
    v_add_u32 v16, 0xb000, v16
    v_add_u32 v17, 0xb000, v17
    v_add_u32 v18, 0xb000, v18
    s_waitcnt lgkmcnt(10)
    v_mfma_f32_32x32x16_bf16 v[176:191], v[80:83], v[64:67], v[176:191]
    v_mfma_f32_32x32x16_bf16 v[192:207], v[80:83], v[68:71], v[192:207]
    s_waitcnt lgkmcnt(9)
    v_mfma_f32_32x32x16_bf16 v[208:223], v[76:79], v[84:87], v[208:223]
    s_waitcnt lgkmcnt(0)
    v_mfma_f32_32x32x16_bf16 v[112:127], v[96:99], v[88:91], v[112:127]
    s_barrier
    ds_read_b32 v49, v48 offset:31872
    ds_read_b32 v50, v54 offset:31872
    ds_read_b64 v[52:53], v2 offset:31808
    v_mfma_f32_32x32x16_bf16 v[128:143], v[96:99], v[92:95], v[128:143]
    ds_read_b32 v51, v55 offset:32384
    ds_read_b128 v[224:227], v8
    ds_read_b64_tr_b16 v[64:65], v17 offset:0
    v_mfma_f32_32x32x16_bf16 v[144:159], v[100:103], v[88:91], v[144:159]
    ds_read_b64_tr_b16 v[66:67], v17 offset:1792
    ds_read_b128 v[228:231], v12
    ds_read_b128 v[68:71], v20 offset:14336
    v_mfma_f32_32x32x16_bf16 v[160:175], v[100:103], v[92:95], v[160:175]
    ds_read_b128 v[232:235], v9
    ds_read_b64_tr_b16 v[72:73], v17 offset:7168
    ds_read_b64_tr_b16 v[74:75], v17 offset:8960
    s_waitcnt lgkmcnt(8)
    v_and_b32 v29, 0xffff0000, v49
    v_mfma_f32_32x32x16_bf16 v[176:191], v[104:107], v[88:91], v[176:191]
    ds_read_b128 v[236:239], v13
    ds_read_b128 v[76:79], v21 offset:14336
    ds_read_b128 v[240:243], v10
    v_and_b32 v36, 0xffff, v49
    v_xor_b32 v36, 0x8000, v36
    v_mfma_f32_32x32x16_bf16 v[192:207], v[104:107], v[92:95], v[192:207]
    ds_read_b64_tr_b16 v[80:81], v17 offset:14336
    ds_read_b64_tr_b16 v[82:83], v17 offset:16128
    ds_read_b128 v[244:247], v14
    v_lshl_or_b32 v36, v36, 16, v36
    v_mov_b32 v37, v36
    v_mfma_f32_32x32x16_bf16 v[208:223], v[100:103], v[108:111], v[208:223]
    ds_read_b128 v[84:87], v22 offset:14336
    ds_read_b128 v[248:251], v11
    ds_read_b64_tr_b16 v[88:89], v17 offset:21504
    v_mov_b32 v38, v36
    v_mov_b32 v39, v36
    s_waitcnt lgkmcnt(14)
    v_mfma_f32_32x32x16_bf16 v[144:159], v[64:67], v[224:227], v[144:159]
    ds_read_b64_tr_b16 v[90:91], v17 offset:23296
    ds_read_b128 v[252:255], v15
    v_and_b32 v30, 0xffff0000, v50
    v_and_b32 v40, 0xffff, v50
    v_xor_b32 v40, 0x8000, v40
    s_waitcnt lgkmcnt(15)
    v_mfma_f32_32x32x16_bf16 v[160:175], v[64:67], v[228:231], v[160:175]
    ds_read_b128 v[92:95], v23 offset:14336
    ds_read_b128 v[96:99], v25
    v_lshl_or_b32 v40, v40, 16, v40
    v_mov_b32 v41, v40
    v_mov_b32 v42, v40
    s_waitcnt lgkmcnt(15)
    v_mfma_f32_32x32x16_bf16 v[208:223], v[64:67], v[68:71], v[208:223]
    ds_read_b64_tr_b16 v[100:101], v18 offset:0
    ds_read_b64_tr_b16 v[102:103], v18 offset:1792
    v_mov_b32 v43, v40
    v_and_b32 v33, 0xffff0000, v51
    v_and_b32 v44, 0xffff, v51
    s_waitcnt lgkmcnt(15)
    v_mfma_f32_32x32x16_bf16 v[144:159], v[72:75], v[232:235], v[144:159]
    ds_read_b64_tr_b16 v[104:105], v18 offset:7168
    ds_read_b64_tr_b16 v[106:107], v18 offset:8960
    v_xor_b32 v44, 0x8000, v44
    v_lshl_or_b32 v44, v44, 16, v44
    v_mov_b32 v45, v44
    s_waitcnt lgkmcnt(15)
    v_mfma_f32_32x32x16_bf16 v[160:175], v[72:75], v[236:239], v[160:175]
    ds_read_b64_tr_b16 v[108:109], v18 offset:14336
    ds_read_b64_tr_b16 v[110:111], v18 offset:16128
    v_mov_b32 v46, v44
    v_mov_b32 v47, v44
    v_rcp_f32 v33, v33
    v_mfma_f32_32x32x16_bf16 v[208:223], v[72:75], v[76:79], v[208:223]
    ds_read_b64_tr_b16 v[64:65], v18 offset:21504
    ds_read_b64_tr_b16 v[66:67], v18 offset:23296
    v_rcp_f32 v31, v29
    v_rcp_f32 v32, v30
    s_waitcnt lgkmcnt(15)
    v_mfma_f32_32x32x16_bf16 v[144:159], v[80:83], v[240:243], v[144:159]
    ds_read_b128 v[68:71], v26
    ds_read_b64_tr_b16 v[72:73], v16 offset:0
    v_readfirstlane_b32 s88, v52
    v_readfirstlane_b32 s89, v53
    v_mul_f32 v34, 0x3eb8aa3b, v31
    v_mfma_f32_32x32x16_bf16 v[160:175], v[80:83], v[244:247], v[160:175]
    ds_read_b64_tr_b16 v[74:75], v16 offset:1792
    ds_read_b64_tr_b16 v[76:77], v16 offset:7168
    v_mul_f32 v35, 0x3eb8aa3b, v32
    s_waitcnt lgkmcnt(15)
    v_mfma_f32_32x32x16_bf16 v[208:223], v[80:83], v[84:87], v[208:223]
    ds_read_b64_tr_b16 v[78:79], v16 offset:8960
    ds_read_b64_tr_b16 v[80:81], v16 offset:14336
    v_mfma_f32_32x32x16_bf16 v[144:159], v[88:91], v[248:251], v[144:159]
    ds_read_b64_tr_b16 v[82:83], v16 offset:16128
    ds_read_b64_tr_b16 v[84:85], v16 offset:21504
    s_waitcnt lgkmcnt(15)
    v_mfma_f32_32x32x16_bf16 v[160:175], v[88:91], v[252:255], v[160:175]
    ds_read_b64_tr_b16 v[86:87], v16 offset:23296
    v_mfma_f32_32x32x16_bf16 v[208:223], v[88:91], v[92:95], v[208:223]
    ds_read_b128 v[88:91], v24
    v_mfma_f32_32x32x16_bf16 v[144:159], v[96:99], v[36:39], v[144:159]
    v_mfma_f32_32x32x16_bf16 v[160:175], v[96:99], v[40:43], v[160:175]
    v_mfma_f32_32x32x16_bf16 v[208:223], v[96:99], v[44:47], v[208:223]
    s_waitcnt lgkmcnt(15)
    v_mfma_f32_32x32x16_bf16 v[176:191], v[100:103], v[224:227], v[176:191]
    v_mfma_f32_32x32x16_bf16 v[192:207], v[100:103], v[228:231], v[192:207]
    v_and_b32 v54, 31, v1
    s_lshl_b32 s67, s55, 5
    v_add_u32 v54, s67, v54
    v_xor_b32 v55, 32, v54
    v_and_b32 v50, 32, v1
    s_waitcnt lgkmcnt(14)
    v_mfma_f32_32x32x16_bf16 v[176:191], v[104:107], v[232:235], v[176:191]
    s_lshl_b32 s68, s74, 6
    s_add_u32 s68, s68, 544
    v_add_u32 v50, s68, v50
    v_mul_u32_u24 v52, 272, v54
    v_mul_u32_u24 v53, 272, v55
    v_mfma_f32_32x32x16_bf16 v[192:207], v[104:107], v[236:239], v[192:207]
    v_add_u32 v52, v52, v50
    v_add_u32 v53, v53, v50
    s_lshl_b32 s67, s57, 7
    v_add_u32 v54, s67, v54
    v_add_u32 v55, s67, v55
    s_waitcnt lgkmcnt(12)
    v_mfma_f32_32x32x16_bf16 v[176:191], v[108:111], v[240:243], v[176:191]
    s_lshl_b32 s67, s73, 7
    s_xor_b32 s68, s67, 128
    v_add_u32 v8, s67, v52
    v_add_u32 v9, s67, v53
    v_add_u32 v10, s68, v52
    v_mfma_f32_32x32x16_bf16 v[192:207], v[108:111], v[244:247], v[192:207]
    v_add_u32 v11, s68, v53
    v_and_b32 v12, 15, v1
    v_mul_u32_u24 v12, 272, v12
    v_add3_u32 v12, v12, v50, s67
    v_subrev_u32 v12, 544, v12
    s_waitcnt lgkmcnt(10)
    v_mfma_f32_32x32x16_bf16 v[176:191], v[64:67], v[248:251], v[176:191]
    s_mov_b32 s75, 0x05040100
    s_mov_b32 s76, 0x07060302
    v_mov_b32 v51, 0xf149f2ca
    v_mul_f32 v144, v144, v31
    v_mul_f32 v145, v145, v31
    v_mfma_f32_32x32x16_bf16 v[192:207], v[64:67], v[252:255], v[192:207]
    v_mul_f32 v146, v146, v31
    v_mul_f32 v147, v147, v31
    v_mul_f32 v148, v148, v31
    v_mul_f32 v149, v149, v31
    v_mul_f32 v150, v150, v31
    s_waitcnt lgkmcnt(9)
    v_mfma_f32_32x32x16_bf16 v[176:191], v[68:71], v[36:39], v[176:191]
    v_mul_f32 v151, v151, v31
    v_mul_f32 v152, v152, v31
    v_mul_f32 v153, v153, v31
    v_mul_f32 v154, v154, v31
    v_mul_f32 v155, v155, v31
    v_mfma_f32_32x32x16_bf16 v[192:207], v[68:71], v[40:43], v[192:207]
    v_mul_f32 v156, v156, v31
    v_mul_f32 v157, v157, v31
    v_mul_f32 v158, v158, v31
    v_mul_f32 v159, v159, v31
    v_cvt_pk_bf16_f32 v144, v144, v145
    s_waitcnt lgkmcnt(7)
    v_mfma_f32_32x32x16_bf16 v[112:127], v[72:75], v[224:227], v[112:127]
    v_cvt_pk_bf16_f32 v145, v146, v147
    v_cvt_pk_bf16_f32 v146, v148, v149
    v_cvt_pk_bf16_f32 v147, v150, v151
    v_cvt_pk_bf16_f32 v148, v152, v153
    v_cvt_pk_bf16_f32 v149, v154, v155
    v_mfma_f32_32x32x16_bf16 v[128:143], v[72:75], v[228:231], v[128:143]
    v_cvt_pk_bf16_f32 v150, v156, v157
    v_cvt_pk_bf16_f32 v151, v158, v159
    ds_write_b128 v8, v[144:147] offset:3808
    ds_write_b128 v8, v[148:151] offset:3824
    v_mul_f32 v160, v160, v32
    s_waitcnt lgkmcnt(7)
    v_mfma_f32_32x32x16_bf16 v[112:127], v[76:79], v[232:235], v[112:127]
    v_mul_f32 v161, v161, v32
    v_mul_f32 v162, v162, v32
    v_mul_f32 v163, v163, v32
    v_mul_f32 v164, v164, v32
    v_mul_f32 v165, v165, v32
    v_mfma_f32_32x32x16_bf16 v[128:143], v[76:79], v[236:239], v[128:143]
    v_mul_f32 v166, v166, v32
    v_mul_f32 v167, v167, v32
    v_mul_f32 v168, v168, v32
    v_mul_f32 v169, v169, v32
    v_mul_f32 v170, v170, v32
    s_waitcnt lgkmcnt(5)
    v_mfma_f32_32x32x16_bf16 v[112:127], v[80:83], v[240:243], v[112:127]
    v_mul_f32 v171, v171, v32
    v_mul_f32 v172, v172, v32
    v_mul_f32 v173, v173, v32
    v_mul_f32 v174, v174, v32
    v_mul_f32 v175, v175, v32
    v_mfma_f32_32x32x16_bf16 v[128:143], v[80:83], v[244:247], v[128:143]
    v_cvt_pk_bf16_f32 v160, v160, v161
    v_cvt_pk_bf16_f32 v161, v162, v163
    v_cvt_pk_bf16_f32 v162, v164, v165
    v_cvt_pk_bf16_f32 v163, v166, v167
    v_cvt_pk_bf16_f32 v164, v168, v169
    s_waitcnt lgkmcnt(3)
    v_mfma_f32_32x32x16_bf16 v[112:127], v[84:87], v[248:251], v[112:127]
    v_cvt_pk_bf16_f32 v165, v170, v171
    v_cvt_pk_bf16_f32 v166, v172, v173
    v_cvt_pk_bf16_f32 v167, v174, v175
    ds_write_b128 v9, v[160:163] offset:3808
    ds_write_b128 v9, v[164:167] offset:3824
    v_mfma_f32_32x32x16_bf16 v[128:143], v[84:87], v[252:255], v[128:143]
    v_mul_f32 v208, v208, v33
    v_mul_f32 v209, v209, v33
    v_mul_f32 v210, v210, v33
    v_mul_f32 v211, v211, v33
    v_mul_f32 v212, v212, v33
    s_waitcnt lgkmcnt(4)
    v_mfma_f32_32x32x16_bf16 v[112:127], v[88:91], v[36:39], v[112:127]
    v_mul_f32 v213, v213, v33
    v_mul_f32 v214, v214, v33
    v_mul_f32 v215, v215, v33
    v_mul_f32 v216, v216, v33
    v_mul_f32 v217, v217, v33
    v_mfma_f32_32x32x16_bf16 v[128:143], v[88:91], v[40:43], v[128:143]
    v_mul_f32 v218, v218, v33
    v_mul_f32 v219, v219, v33
    v_mul_f32 v220, v220, v33
    v_mul_f32 v221, v221, v33
    v_mul_f32 v222, v222, v33
    s_mov_b64 exec, 1
    ds_add_u32 v2, v3 offset:32544
    s_mov_b64 exec, -1
    v_mul_f32 v223, v223, v33
    v_cvt_pk_bf16_f32 v208, v208, v209
    v_cvt_pk_bf16_f32 v209, v210, v211
    v_cvt_pk_bf16_f32 v210, v212, v213
    v_cvt_pk_bf16_f32 v211, v214, v215
    v_cvt_pk_bf16_f32 v212, v216, v217
    v_cvt_pk_bf16_f32 v213, v218, v219
    v_cvt_pk_bf16_f32 v214, v220, v221
    v_cvt_pk_bf16_f32 v215, v222, v223
    ds_write_b128 v12, v[208:211] offset:0
    ds_write_b128 v12, v[212:215] offset:16
    v_mul_f32 v176, v176, v31
    v_mul_f32 v177, v177, v31
    v_mul_f32 v178, v178, v31
    v_mul_f32 v179, v179, v31
    v_mul_f32 v180, v180, v31
    v_mul_f32 v181, v181, v31
    v_mul_f32 v182, v182, v31
    v_mul_f32 v183, v183, v31
    v_mul_f32 v184, v184, v31
    v_mul_f32 v185, v185, v31
    v_mul_f32 v186, v186, v31
    v_mul_f32 v187, v187, v31
    v_mul_f32 v188, v188, v31
    v_mul_f32 v189, v189, v31
    v_mul_f32 v190, v190, v31
    v_mul_f32 v191, v191, v31
    v_cvt_pk_bf16_f32 v176, v176, v177
    v_cvt_pk_bf16_f32 v177, v178, v179
    v_cvt_pk_bf16_f32 v178, v180, v181
    v_cvt_pk_bf16_f32 v179, v182, v183
    v_cvt_pk_bf16_f32 v180, v184, v185
    v_cvt_pk_bf16_f32 v181, v186, v187
    v_cvt_pk_bf16_f32 v182, v188, v189
    v_cvt_pk_bf16_f32 v183, v190, v191
    ds_write_b128 v10, v[176:179] offset:3808
    ds_write_b128 v10, v[180:183] offset:3824
    v_mul_f32 v192, v192, v32
    v_mul_f32 v193, v193, v32
    v_mul_f32 v194, v194, v32
    v_mul_f32 v195, v195, v32
    v_mul_f32 v196, v196, v32
    v_mul_f32 v197, v197, v32
    v_mul_f32 v198, v198, v32
    v_mul_f32 v199, v199, v32
    v_mul_f32 v200, v200, v32
    v_mul_f32 v201, v201, v32
    v_mul_f32 v202, v202, v32
    v_mul_f32 v203, v203, v32
    v_mul_f32 v204, v204, v32
    v_mul_f32 v205, v205, v32
    v_mul_f32 v206, v206, v32
    v_mul_f32 v207, v207, v32
    v_cvt_pk_bf16_f32 v192, v192, v193
    v_cvt_pk_bf16_f32 v193, v194, v195
    v_cvt_pk_bf16_f32 v194, v196, v197
    v_cvt_pk_bf16_f32 v195, v198, v199
    v_cvt_pk_bf16_f32 v196, v200, v201
    v_cvt_pk_bf16_f32 v197, v202, v203
    v_cvt_pk_bf16_f32 v198, v204, v205
    v_cvt_pk_bf16_f32 v199, v206, v207
    ds_write_b128 v11, v[192:195] offset:3808
    ds_write_b128 v11, v[196:199] offset:3824
    s_mov_b64 exec, 1
    ds_add_u32 v2, v3 offset:32576
    s_mov_b64 exec, -1
    v_cvt_pk_bf16_f32 v112, v112, v113
    v_cvt_pk_bf16_f32 v113, v114, v115
    v_cvt_pk_bf16_f32 v114, v116, v117
    v_cvt_pk_bf16_f32 v115, v118, v119
    v_cvt_pk_bf16_f32 v116, v120, v121
    v_cvt_pk_bf16_f32 v117, v122, v123
    v_cvt_pk_bf16_f32 v118, v124, v125
    v_cvt_pk_bf16_f32 v119, v126, v127
    v_cvt_pk_bf16_f32 v128, v128, v129
    v_cvt_pk_bf16_f32 v129, v130, v131
    v_cvt_pk_bf16_f32 v130, v132, v133
    v_cvt_pk_bf16_f32 v131, v134, v135
    v_cvt_pk_bf16_f32 v132, v136, v137
    v_cvt_pk_bf16_f32 v133, v138, v139
    v_cvt_pk_bf16_f32 v134, v140, v141
    v_cvt_pk_bf16_f32 v135, v142, v143
    s_mov_b32 s7, 0
T_c1:
    ds_read_b32 v4, v2 offset:32576
    s_waitcnt lgkmcnt(0)
    v_readfirstlane_b32 s3, v4
    s_nop 0
    s_cmp_ge_u32 s3, 4
    s_cbranch_scc1 T_c1k
    s_add_u32 s7, s7, 1
    s_cmp_ge_u32 s7, 0x200000
    s_cbranch_scc1 T_c1k
    s_nop 7
    s_nop 7
    s_branch T_c1
T_c1k:
    ds_read_b128 v[144:147], v52 offset:3808
    ds_read_b128 v[148:151], v52 offset:3824
    ds_read_b128 v[152:155], v52 offset:3264
    ds_read_b128 v[156:159], v52 offset:3280
    ds_read_b128 v[160:163], v52 offset:2720
    ds_read_b128 v[164:167], v52 offset:2736
    ds_read_b128 v[168:171], v52 offset:2176
    ds_read_b128 v[172:175], v52 offset:2192
    ds_read_b128 v[176:179], v52 offset:1632
    ds_read_b128 v[180:183], v52 offset:1648
    ds_read_b128 v[184:187], v52 offset:1088
    ds_read_b128 v[188:191], v52 offset:1104
    ds_read_b128 v[192:195], v52 offset:544
    ds_read_b128 v[196:199], v52 offset:560
    ds_read_b128 v[200:203], v52 offset:0
    s_waitcnt lgkmcnt(13)
    ds_read_b128 v[204:207], v52 offset:16
    v_mov_b32 v8, 0
    v_cmp_gt_u32 vcc, 2, v54
    s_nop 1
    v_cndmask_b32 v9, 0, v51, vcc
    v_cmp_gt_u32 vcc, 4, v54
    s_nop 1
    v_cndmask_b32 v10, 0, v51, vcc
    v_cmp_gt_u32 vcc, 6, v54
    s_nop 1
    v_cndmask_b32 v11, 0, v51, vcc
    v_cmp_gt_u32 vcc, 8, v54
    s_nop 1
    v_cndmask_b32 v12, 0, v51, vcc
    v_cmp_gt_u32 vcc, 10, v54
    s_nop 1
    v_cndmask_b32 v13, 0, v51, vcc
    v_cmp_gt_u32 vcc, 12, v54
    s_nop 1
    v_cndmask_b32 v14, 0, v51, vcc
    v_cmp_gt_u32 vcc, 14, v54
    s_nop 1
    v_cndmask_b32 v15, 0, v51, vcc
    ds_read_b128 v[64:67], v52 offset:3936
    s_waitcnt lgkmcnt(13)
    ds_read_b128 v[68:71], v52 offset:3952
    v_dot2c_f32_bf16 v8, v112, v144
    v_dot2c_f32_bf16 v8, v113, v145
    v_dot2c_f32_bf16 v8, v114, v146
    v_dot2c_f32_bf16 v8, v115, v147
    v_dot2c_f32_bf16 v8, v116, v148
    v_dot2c_f32_bf16 v8, v117, v149
    v_dot2c_f32_bf16 v8, v118, v150
    v_dot2c_f32_bf16 v8, v119, v151
    ds_read_b128 v[72:75], v52 offset:3392
    s_waitcnt lgkmcnt(13)
    ds_read_b128 v[76:79], v52 offset:3408
    v_dot2c_f32_bf16 v9, v112, v152
    v_dot2c_f32_bf16 v9, v113, v153
    v_dot2c_f32_bf16 v9, v114, v154
    v_dot2c_f32_bf16 v9, v115, v155
    v_dot2c_f32_bf16 v9, v116, v156
    v_dot2c_f32_bf16 v9, v117, v157
    v_dot2c_f32_bf16 v9, v118, v158
    v_dot2c_f32_bf16 v9, v119, v159
    ds_read_b128 v[80:83], v52 offset:2848
    s_waitcnt lgkmcnt(13)
    ds_read_b128 v[84:87], v52 offset:2864
    v_dot2c_f32_bf16 v10, v112, v160
    v_dot2c_f32_bf16 v10, v113, v161
    v_dot2c_f32_bf16 v10, v114, v162
    v_dot2c_f32_bf16 v10, v115, v163
    v_dot2c_f32_bf16 v10, v116, v164
    v_dot2c_f32_bf16 v10, v117, v165
    v_dot2c_f32_bf16 v10, v118, v166
    v_dot2c_f32_bf16 v10, v119, v167
    ds_read_b128 v[88:91], v52 offset:2304
    s_waitcnt lgkmcnt(13)
    ds_read_b128 v[92:95], v52 offset:2320
    v_dot2c_f32_bf16 v11, v112, v168
    v_dot2c_f32_bf16 v11, v113, v169
    v_dot2c_f32_bf16 v11, v114, v170
    v_dot2c_f32_bf16 v11, v115, v171
    v_dot2c_f32_bf16 v11, v116, v172
    v_dot2c_f32_bf16 v11, v117, v173
    v_dot2c_f32_bf16 v11, v118, v174
    v_dot2c_f32_bf16 v11, v119, v175
    ds_read_b128 v[96:99], v52 offset:1760
    s_waitcnt lgkmcnt(13)
    ds_read_b128 v[100:103], v52 offset:1776
    v_dot2c_f32_bf16 v12, v112, v176
    v_dot2c_f32_bf16 v12, v113, v177
    v_dot2c_f32_bf16 v12, v114, v178
    v_dot2c_f32_bf16 v12, v115, v179
    v_dot2c_f32_bf16 v12, v116, v180
    v_dot2c_f32_bf16 v12, v117, v181
    v_dot2c_f32_bf16 v12, v118, v182
    v_dot2c_f32_bf16 v12, v119, v183
    ds_read_b128 v[104:107], v52 offset:1216
    s_waitcnt lgkmcnt(13)
    ds_read_b128 v[108:111], v52 offset:1232
    v_dot2c_f32_bf16 v13, v112, v184
    v_dot2c_f32_bf16 v13, v113, v185
    v_dot2c_f32_bf16 v13, v114, v186
    v_dot2c_f32_bf16 v13, v115, v187
    v_dot2c_f32_bf16 v13, v116, v188
    v_dot2c_f32_bf16 v13, v117, v189
    v_dot2c_f32_bf16 v13, v118, v190
    v_dot2c_f32_bf16 v13, v119, v191
    ds_read_b128 v[208:211], v52 offset:672
    s_waitcnt lgkmcnt(13)
    ds_read_b128 v[212:215], v52 offset:688
    v_dot2c_f32_bf16 v14, v112, v192
    v_dot2c_f32_bf16 v14, v113, v193
    v_dot2c_f32_bf16 v14, v114, v194
    v_dot2c_f32_bf16 v14, v115, v195
    v_dot2c_f32_bf16 v14, v116, v196
    v_dot2c_f32_bf16 v14, v117, v197
    v_dot2c_f32_bf16 v14, v118, v198
    v_dot2c_f32_bf16 v14, v119, v199
    ds_read_b128 v[216:219], v52 offset:128
    s_waitcnt lgkmcnt(13)
    ds_read_b128 v[220:223], v52 offset:144
    v_dot2c_f32_bf16 v15, v112, v200
    v_dot2c_f32_bf16 v15, v113, v201
    v_dot2c_f32_bf16 v15, v114, v202
    v_dot2c_f32_bf16 v15, v115, v203
    v_dot2c_f32_bf16 v15, v116, v204
    v_dot2c_f32_bf16 v15, v117, v205
    v_dot2c_f32_bf16 v15, v118, v206
    v_dot2c_f32_bf16 v15, v119, v207
    v_max3_f32 v20, v8, v9, v10
    v_max3_f32 v21, v11, v12, v13
    s_nop 0
    v_max3_f32 v20, v20, v14, v15
    v_max_f32 v20, v20, v21
    v_mul_f32 v20, v20, v34
    v_fma_f32 v8, v8, v34, -v20
    v_fma_f32 v9, v9, v34, -v20
    v_fma_f32 v10, v10, v34, -v20
    v_fma_f32 v11, v11, v34, -v20
    v_fma_f32 v12, v12, v34, -v20
    v_fma_f32 v13, v13, v34, -v20
    v_fma_f32 v14, v14, v34, -v20
    v_fma_f32 v15, v15, v34, -v20
    v_exp_f32 v8, v8
    v_exp_f32 v9, v9
    v_exp_f32 v10, v10
    v_exp_f32 v11, v11
    v_exp_f32 v12, v12
    v_exp_f32 v13, v13
    v_exp_f32 v14, v14
    v_exp_f32 v15, v15
    v_add_f32 v20, v8, v9
    v_add_f32 v21, v10, v11
    v_add_f32 v22, v12, v13
    v_add_f32 v23, v14, v15
    v_add_f32 v20, v20, v21
    v_add_f32 v22, v22, v23
    v_add_f32 v20, v20, v22
    v_rcp_f32 v20, v20
    s_nop 0
    v_mul_f32 v8, v8, v20
    v_mul_f32 v9, v9, v20
    v_mul_f32 v10, v10, v20
    v_mul_f32 v11, v11, v20
    v_mul_f32 v12, v12, v20
    v_mul_f32 v13, v13, v20
    v_mul_f32 v14, v14, v20
    v_mul_f32 v15, v15, v20
    v_cvt_pk_bf16_f32 v16, v8, v9
    v_cvt_pk_bf16_f32 v17, v10, v11
    v_cvt_pk_bf16_f32 v18, v12, v13
    v_cvt_pk_bf16_f32 v19, v14, v15
    v_mov_b32 v224, 0
    v_mov_b32 v225, 0
    v_mov_b32 v226, 0
    v_mov_b32 v227, 0
    v_mov_b32 v228, 0
    v_mov_b32 v229, 0
    v_mov_b32 v230, 0
    v_mov_b32 v231, 0
    v_mov_b32 v232, 0
    v_mov_b32 v233, 0
    v_mov_b32 v234, 0
    v_mov_b32 v235, 0
    v_mov_b32 v236, 0
    v_mov_b32 v237, 0
    v_mov_b32 v238, 0
    v_mov_b32 v239, 0
    s_waitcnt lgkmcnt(12)
    v_perm_b32 v144, v72, v64, s75
    v_perm_b32 v145, v72, v64, s76
    v_perm_b32 v146, v73, v65, s75
    v_perm_b32 v147, v73, v65, s76
    v_perm_b32 v148, v74, v66, s75
    v_perm_b32 v149, v74, v66, s76
    v_perm_b32 v150, v75, v67, s75
    v_perm_b32 v151, v75, v67, s76
    v_perm_b32 v152, v76, v68, s75
    v_perm_b32 v153, v76, v68, s76
    v_perm_b32 v154, v77, v69, s75
    v_perm_b32 v155, v77, v69, s76
    v_perm_b32 v156, v78, v70, s75
    v_perm_b32 v157, v78, v70, s76
    v_perm_b32 v158, v79, v71, s75
    v_perm_b32 v159, v79, v71, s76
    v_dot2c_f32_bf16 v224, v144, v16
    v_dot2c_f32_bf16 v225, v145, v16
    v_dot2c_f32_bf16 v226, v146, v16
    v_dot2c_f32_bf16 v227, v147, v16
    v_dot2c_f32_bf16 v228, v148, v16
    v_dot2c_f32_bf16 v229, v149, v16
    v_dot2c_f32_bf16 v230, v150, v16
    v_dot2c_f32_bf16 v231, v151, v16
    v_dot2c_f32_bf16 v232, v152, v16
    v_dot2c_f32_bf16 v233, v153, v16
    v_dot2c_f32_bf16 v234, v154, v16
    v_dot2c_f32_bf16 v235, v155, v16
    v_dot2c_f32_bf16 v236, v156, v16
    v_dot2c_f32_bf16 v237, v157, v16
    v_dot2c_f32_bf16 v238, v158, v16
    v_dot2c_f32_bf16 v239, v159, v16
    s_waitcnt lgkmcnt(8)
    v_perm_b32 v144, v88, v80, s75
    v_perm_b32 v145, v88, v80, s76
    v_perm_b32 v146, v89, v81, s75
    v_perm_b32 v147, v89, v81, s76
    v_perm_b32 v148, v90, v82, s75
    v_perm_b32 v149, v90, v82, s76
    v_perm_b32 v150, v91, v83, s75
    v_perm_b32 v151, v91, v83, s76
    v_perm_b32 v152, v92, v84, s75
    v_perm_b32 v153, v92, v84, s76
    v_perm_b32 v154, v93, v85, s75
    v_perm_b32 v155, v93, v85, s76
    v_perm_b32 v156, v94, v86, s75
    v_perm_b32 v157, v94, v86, s76
    v_perm_b32 v158, v95, v87, s75
    v_perm_b32 v159, v95, v87, s76
    v_dot2c_f32_bf16 v224, v144, v17
    v_dot2c_f32_bf16 v225, v145, v17
    v_dot2c_f32_bf16 v226, v146, v17
    v_dot2c_f32_bf16 v227, v147, v17
    v_dot2c_f32_bf16 v228, v148, v17
    v_dot2c_f32_bf16 v229, v149, v17
    v_dot2c_f32_bf16 v230, v150, v17
    v_dot2c_f32_bf16 v231, v151, v17
    v_dot2c_f32_bf16 v232, v152, v17
    v_dot2c_f32_bf16 v233, v153, v17
    v_dot2c_f32_bf16 v234, v154, v17
    v_dot2c_f32_bf16 v235, v155, v17
    v_dot2c_f32_bf16 v236, v156, v17
    v_dot2c_f32_bf16 v237, v157, v17
    v_dot2c_f32_bf16 v238, v158, v17
    v_dot2c_f32_bf16 v239, v159, v17
    s_waitcnt lgkmcnt(4)
    v_perm_b32 v144, v104, v96, s75
    v_perm_b32 v145, v104, v96, s76
    v_perm_b32 v146, v105, v97, s75
    v_perm_b32 v147, v105, v97, s76
    v_perm_b32 v148, v106, v98, s75
    v_perm_b32 v149, v106, v98, s76
    v_perm_b32 v150, v107, v99, s75
    v_perm_b32 v151, v107, v99, s76
    v_perm_b32 v152, v108, v100, s75
    v_perm_b32 v153, v108, v100, s76
    v_perm_b32 v154, v109, v101, s75
    v_perm_b32 v155, v109, v101, s76
    v_perm_b32 v156, v110, v102, s75
    v_perm_b32 v157, v110, v102, s76
    v_perm_b32 v158, v111, v103, s75
    v_perm_b32 v159, v111, v103, s76
    v_dot2c_f32_bf16 v224, v144, v18
    v_dot2c_f32_bf16 v225, v145, v18
    v_dot2c_f32_bf16 v226, v146, v18
    v_dot2c_f32_bf16 v227, v147, v18
    v_dot2c_f32_bf16 v228, v148, v18
    v_dot2c_f32_bf16 v229, v149, v18
    v_dot2c_f32_bf16 v230, v150, v18
    v_dot2c_f32_bf16 v231, v151, v18
    v_dot2c_f32_bf16 v232, v152, v18
    v_dot2c_f32_bf16 v233, v153, v18
    v_dot2c_f32_bf16 v234, v154, v18
    v_dot2c_f32_bf16 v235, v155, v18
    v_dot2c_f32_bf16 v236, v156, v18
    v_dot2c_f32_bf16 v237, v157, v18
    v_dot2c_f32_bf16 v238, v158, v18
    v_dot2c_f32_bf16 v239, v159, v18
    s_waitcnt lgkmcnt(0)
    v_perm_b32 v144, v216, v208, s75
    v_perm_b32 v145, v216, v208, s76
    v_perm_b32 v146, v217, v209, s75
    v_perm_b32 v147, v217, v209, s76
    v_perm_b32 v148, v218, v210, s75
    v_perm_b32 v149, v218, v210, s76
    v_perm_b32 v150, v219, v211, s75
    v_perm_b32 v151, v219, v211, s76
    v_perm_b32 v152, v220, v212, s75
    v_perm_b32 v153, v220, v212, s76
    v_perm_b32 v154, v221, v213, s75
    v_perm_b32 v155, v221, v213, s76
    v_perm_b32 v156, v222, v214, s75
    v_perm_b32 v157, v222, v214, s76
    v_perm_b32 v158, v223, v215, s75
    v_perm_b32 v159, v223, v215, s76
    v_dot2c_f32_bf16 v224, v144, v19
    v_dot2c_f32_bf16 v225, v145, v19
    v_dot2c_f32_bf16 v226, v146, v19
    v_dot2c_f32_bf16 v227, v147, v19
    v_dot2c_f32_bf16 v228, v148, v19
    v_dot2c_f32_bf16 v229, v149, v19
    v_dot2c_f32_bf16 v230, v150, v19
    v_dot2c_f32_bf16 v231, v151, v19
    v_dot2c_f32_bf16 v232, v152, v19
    v_dot2c_f32_bf16 v233, v153, v19
    v_dot2c_f32_bf16 v234, v154, v19
    v_dot2c_f32_bf16 v235, v155, v19
    v_dot2c_f32_bf16 v236, v156, v19
    v_dot2c_f32_bf16 v237, v157, v19
    v_dot2c_f32_bf16 v238, v158, v19
    v_dot2c_f32_bf16 v239, v159, v19
    v_cvt_pk_bf16_f32 v120, v224, v225
    v_cvt_pk_bf16_f32 v121, v226, v227
    v_cvt_pk_bf16_f32 v122, v228, v229
    v_cvt_pk_bf16_f32 v123, v230, v231
    v_cvt_pk_bf16_f32 v124, v232, v233
    v_cvt_pk_bf16_f32 v125, v234, v235
    v_cvt_pk_bf16_f32 v126, v236, v237
    v_cvt_pk_bf16_f32 v127, v238, v239
    ds_read_b128 v[144:147], v53 offset:3808
    ds_read_b128 v[148:151], v53 offset:3824
    ds_read_b128 v[152:155], v53 offset:3264
    ds_read_b128 v[156:159], v53 offset:3280
    ds_read_b128 v[160:163], v53 offset:2720
    ds_read_b128 v[164:167], v53 offset:2736
    ds_read_b128 v[168:171], v53 offset:2176
    ds_read_b128 v[172:175], v53 offset:2192
    ds_read_b128 v[176:179], v53 offset:1632
    ds_read_b128 v[180:183], v53 offset:1648
    ds_read_b128 v[184:187], v53 offset:1088
    ds_read_b128 v[188:191], v53 offset:1104
    ds_read_b128 v[192:195], v53 offset:544
    ds_read_b128 v[196:199], v53 offset:560
    ds_read_b128 v[200:203], v53 offset:0
    s_waitcnt lgkmcnt(13)
    ds_read_b128 v[204:207], v53 offset:16
    v_mov_b32 v8, 0
    v_cmp_gt_u32 vcc, 2, v55
    s_nop 1
    v_cndmask_b32 v9, 0, v51, vcc
    v_cmp_gt_u32 vcc, 4, v55
    s_nop 1
    v_cndmask_b32 v10, 0, v51, vcc
    v_cmp_gt_u32 vcc, 6, v55
    s_nop 1
    v_cndmask_b32 v11, 0, v51, vcc
    v_cmp_gt_u32 vcc, 8, v55
    s_nop 1
    v_cndmask_b32 v12, 0, v51, vcc
    v_cmp_gt_u32 vcc, 10, v55
    s_nop 1
    v_cndmask_b32 v13, 0, v51, vcc
    v_cmp_gt_u32 vcc, 12, v55
    s_nop 1
    v_cndmask_b32 v14, 0, v51, vcc
    v_cmp_gt_u32 vcc, 14, v55
    s_nop 1
    v_cndmask_b32 v15, 0, v51, vcc
    ds_read_b128 v[64:67], v53 offset:3936
    s_waitcnt lgkmcnt(13)
    ds_read_b128 v[68:71], v53 offset:3952
    v_dot2c_f32_bf16 v8, v128, v144
    v_dot2c_f32_bf16 v8, v129, v145
    v_dot2c_f32_bf16 v8, v130, v146
    v_dot2c_f32_bf16 v8, v131, v147
    v_dot2c_f32_bf16 v8, v132, v148
    v_dot2c_f32_bf16 v8, v133, v149
    v_dot2c_f32_bf16 v8, v134, v150
    v_dot2c_f32_bf16 v8, v135, v151
    ds_read_b128 v[72:75], v53 offset:3392
    s_waitcnt lgkmcnt(13)
    ds_read_b128 v[76:79], v53 offset:3408
    v_dot2c_f32_bf16 v9, v128, v152
    v_dot2c_f32_bf16 v9, v129, v153
    v_dot2c_f32_bf16 v9, v130, v154
    v_dot2c_f32_bf16 v9, v131, v155
    v_dot2c_f32_bf16 v9, v132, v156
    v_dot2c_f32_bf16 v9, v133, v157
    v_dot2c_f32_bf16 v9, v134, v158
    v_dot2c_f32_bf16 v9, v135, v159
    ds_read_b128 v[80:83], v53 offset:2848
    s_waitcnt lgkmcnt(13)
    ds_read_b128 v[84:87], v53 offset:2864
    v_dot2c_f32_bf16 v10, v128, v160
    v_dot2c_f32_bf16 v10, v129, v161
    v_dot2c_f32_bf16 v10, v130, v162
    v_dot2c_f32_bf16 v10, v131, v163
    v_dot2c_f32_bf16 v10, v132, v164
    v_dot2c_f32_bf16 v10, v133, v165
    v_dot2c_f32_bf16 v10, v134, v166
    v_dot2c_f32_bf16 v10, v135, v167
    ds_read_b128 v[88:91], v53 offset:2304
    s_waitcnt lgkmcnt(13)
    ds_read_b128 v[92:95], v53 offset:2320
    v_dot2c_f32_bf16 v11, v128, v168
    v_dot2c_f32_bf16 v11, v129, v169
    v_dot2c_f32_bf16 v11, v130, v170
    v_dot2c_f32_bf16 v11, v131, v171
    v_dot2c_f32_bf16 v11, v132, v172
    v_dot2c_f32_bf16 v11, v133, v173
    v_dot2c_f32_bf16 v11, v134, v174
    v_dot2c_f32_bf16 v11, v135, v175
    ds_read_b128 v[96:99], v53 offset:1760
    s_waitcnt lgkmcnt(13)
    ds_read_b128 v[100:103], v53 offset:1776
    v_dot2c_f32_bf16 v12, v128, v176
    v_dot2c_f32_bf16 v12, v129, v177
    v_dot2c_f32_bf16 v12, v130, v178
    v_dot2c_f32_bf16 v12, v131, v179
    v_dot2c_f32_bf16 v12, v132, v180
    v_dot2c_f32_bf16 v12, v133, v181
    v_dot2c_f32_bf16 v12, v134, v182
    v_dot2c_f32_bf16 v12, v135, v183
    ds_read_b128 v[104:107], v53 offset:1216
    s_waitcnt lgkmcnt(13)
    ds_read_b128 v[108:111], v53 offset:1232
    v_dot2c_f32_bf16 v13, v128, v184
    v_dot2c_f32_bf16 v13, v129, v185
    v_dot2c_f32_bf16 v13, v130, v186
    v_dot2c_f32_bf16 v13, v131, v187
    v_dot2c_f32_bf16 v13, v132, v188
    v_dot2c_f32_bf16 v13, v133, v189
    v_dot2c_f32_bf16 v13, v134, v190
    v_dot2c_f32_bf16 v13, v135, v191
    ds_read_b128 v[208:211], v53 offset:672
    s_waitcnt lgkmcnt(13)
    ds_read_b128 v[212:215], v53 offset:688
    v_dot2c_f32_bf16 v14, v128, v192
    v_dot2c_f32_bf16 v14, v129, v193
    v_dot2c_f32_bf16 v14, v130, v194
    v_dot2c_f32_bf16 v14, v131, v195
    v_dot2c_f32_bf16 v14, v132, v196
    v_dot2c_f32_bf16 v14, v133, v197
    v_dot2c_f32_bf16 v14, v134, v198
    v_dot2c_f32_bf16 v14, v135, v199
    ds_read_b128 v[216:219], v53 offset:128
    s_waitcnt lgkmcnt(13)
    ds_read_b128 v[220:223], v53 offset:144
    v_dot2c_f32_bf16 v15, v128, v200
    v_dot2c_f32_bf16 v15, v129, v201
    v_dot2c_f32_bf16 v15, v130, v202
    v_dot2c_f32_bf16 v15, v131, v203
    v_dot2c_f32_bf16 v15, v132, v204
    v_dot2c_f32_bf16 v15, v133, v205
    v_dot2c_f32_bf16 v15, v134, v206
    v_dot2c_f32_bf16 v15, v135, v207
    v_max3_f32 v20, v8, v9, v10
    v_max3_f32 v21, v11, v12, v13
    s_nop 0
    v_max3_f32 v20, v20, v14, v15
    v_max_f32 v20, v20, v21
    v_mul_f32 v20, v20, v35
    v_fma_f32 v8, v8, v35, -v20
    v_fma_f32 v9, v9, v35, -v20
    v_fma_f32 v10, v10, v35, -v20
    v_fma_f32 v11, v11, v35, -v20
    v_fma_f32 v12, v12, v35, -v20
    v_fma_f32 v13, v13, v35, -v20
    v_fma_f32 v14, v14, v35, -v20
    v_fma_f32 v15, v15, v35, -v20
    v_exp_f32 v8, v8
    v_exp_f32 v9, v9
    v_exp_f32 v10, v10
    v_exp_f32 v11, v11
    v_exp_f32 v12, v12
    v_exp_f32 v13, v13
    v_exp_f32 v14, v14
    v_exp_f32 v15, v15
    v_add_f32 v20, v8, v9
    v_add_f32 v21, v10, v11
    v_add_f32 v22, v12, v13
    v_add_f32 v23, v14, v15
    v_add_f32 v20, v20, v21
    v_add_f32 v22, v22, v23
    v_add_f32 v20, v20, v22
    v_rcp_f32 v20, v20
    s_nop 0
    v_mul_f32 v8, v8, v20
    v_mul_f32 v9, v9, v20
    v_mul_f32 v10, v10, v20
    v_mul_f32 v11, v11, v20
    v_mul_f32 v12, v12, v20
    v_mul_f32 v13, v13, v20
    v_mul_f32 v14, v14, v20
    v_mul_f32 v15, v15, v20
    v_cvt_pk_bf16_f32 v16, v8, v9
    v_cvt_pk_bf16_f32 v17, v10, v11
    v_cvt_pk_bf16_f32 v18, v12, v13
    v_cvt_pk_bf16_f32 v19, v14, v15
    v_mov_b32 v224, 0
    v_mov_b32 v225, 0
    v_mov_b32 v226, 0
    v_mov_b32 v227, 0
    v_mov_b32 v228, 0
    v_mov_b32 v229, 0
    v_mov_b32 v230, 0
    v_mov_b32 v231, 0
    v_mov_b32 v232, 0
    v_mov_b32 v233, 0
    v_mov_b32 v234, 0
    v_mov_b32 v235, 0
    v_mov_b32 v236, 0
    v_mov_b32 v237, 0
    v_mov_b32 v238, 0
    v_mov_b32 v239, 0
    s_waitcnt lgkmcnt(12)
    v_perm_b32 v144, v72, v64, s75
    v_perm_b32 v145, v72, v64, s76
    v_perm_b32 v146, v73, v65, s75
    v_perm_b32 v147, v73, v65, s76
    v_perm_b32 v148, v74, v66, s75
    v_perm_b32 v149, v74, v66, s76
    v_perm_b32 v150, v75, v67, s75
    v_perm_b32 v151, v75, v67, s76
    v_perm_b32 v152, v76, v68, s75
    v_perm_b32 v153, v76, v68, s76
    v_perm_b32 v154, v77, v69, s75
    v_perm_b32 v155, v77, v69, s76
    v_perm_b32 v156, v78, v70, s75
    v_perm_b32 v157, v78, v70, s76
    v_perm_b32 v158, v79, v71, s75
    v_perm_b32 v159, v79, v71, s76
    v_dot2c_f32_bf16 v224, v144, v16
    v_dot2c_f32_bf16 v225, v145, v16
    v_dot2c_f32_bf16 v226, v146, v16
    v_dot2c_f32_bf16 v227, v147, v16
    v_dot2c_f32_bf16 v228, v148, v16
    v_dot2c_f32_bf16 v229, v149, v16
    v_dot2c_f32_bf16 v230, v150, v16
    v_dot2c_f32_bf16 v231, v151, v16
    v_dot2c_f32_bf16 v232, v152, v16
    v_dot2c_f32_bf16 v233, v153, v16
    v_dot2c_f32_bf16 v234, v154, v16
    v_dot2c_f32_bf16 v235, v155, v16
    v_dot2c_f32_bf16 v236, v156, v16
    v_dot2c_f32_bf16 v237, v157, v16
    v_dot2c_f32_bf16 v238, v158, v16
    v_dot2c_f32_bf16 v239, v159, v16
    s_waitcnt lgkmcnt(8)
    v_perm_b32 v144, v88, v80, s75
    v_perm_b32 v145, v88, v80, s76
    v_perm_b32 v146, v89, v81, s75
    v_perm_b32 v147, v89, v81, s76
    v_perm_b32 v148, v90, v82, s75
    v_perm_b32 v149, v90, v82, s76
    v_perm_b32 v150, v91, v83, s75
    v_perm_b32 v151, v91, v83, s76
    v_perm_b32 v152, v92, v84, s75
    v_perm_b32 v153, v92, v84, s76
    v_perm_b32 v154, v93, v85, s75
    v_perm_b32 v155, v93, v85, s76
    v_perm_b32 v156, v94, v86, s75
    v_perm_b32 v157, v94, v86, s76
    v_perm_b32 v158, v95, v87, s75
    v_perm_b32 v159, v95, v87, s76
    v_dot2c_f32_bf16 v224, v144, v17
    v_dot2c_f32_bf16 v225, v145, v17
    v_dot2c_f32_bf16 v226, v146, v17
    v_dot2c_f32_bf16 v227, v147, v17
    v_dot2c_f32_bf16 v228, v148, v17
    v_dot2c_f32_bf16 v229, v149, v17
    v_dot2c_f32_bf16 v230, v150, v17
    v_dot2c_f32_bf16 v231, v151, v17
    v_dot2c_f32_bf16 v232, v152, v17
    v_dot2c_f32_bf16 v233, v153, v17
    v_dot2c_f32_bf16 v234, v154, v17
    v_dot2c_f32_bf16 v235, v155, v17
    v_dot2c_f32_bf16 v236, v156, v17
    v_dot2c_f32_bf16 v237, v157, v17
    v_dot2c_f32_bf16 v238, v158, v17
    v_dot2c_f32_bf16 v239, v159, v17
    s_waitcnt lgkmcnt(4)
    v_perm_b32 v144, v104, v96, s75
    v_perm_b32 v145, v104, v96, s76
    v_perm_b32 v146, v105, v97, s75
    v_perm_b32 v147, v105, v97, s76
    v_perm_b32 v148, v106, v98, s75
    v_perm_b32 v149, v106, v98, s76
    v_perm_b32 v150, v107, v99, s75
    v_perm_b32 v151, v107, v99, s76
    v_perm_b32 v152, v108, v100, s75
    v_perm_b32 v153, v108, v100, s76
    v_perm_b32 v154, v109, v101, s75
    v_perm_b32 v155, v109, v101, s76
    v_perm_b32 v156, v110, v102, s75
    v_perm_b32 v157, v110, v102, s76
    v_perm_b32 v158, v111, v103, s75
    v_perm_b32 v159, v111, v103, s76
    v_dot2c_f32_bf16 v224, v144, v18
    v_dot2c_f32_bf16 v225, v145, v18
    v_dot2c_f32_bf16 v226, v146, v18
    v_dot2c_f32_bf16 v227, v147, v18
    v_dot2c_f32_bf16 v228, v148, v18
    v_dot2c_f32_bf16 v229, v149, v18
    v_dot2c_f32_bf16 v230, v150, v18
    v_dot2c_f32_bf16 v231, v151, v18
    v_dot2c_f32_bf16 v232, v152, v18
    v_dot2c_f32_bf16 v233, v153, v18
    v_dot2c_f32_bf16 v234, v154, v18
    v_dot2c_f32_bf16 v235, v155, v18
    v_dot2c_f32_bf16 v236, v156, v18
    v_dot2c_f32_bf16 v237, v157, v18
    v_dot2c_f32_bf16 v238, v158, v18
    v_dot2c_f32_bf16 v239, v159, v18
    s_waitcnt lgkmcnt(0)
    v_perm_b32 v144, v216, v208, s75
    v_perm_b32 v145, v216, v208, s76
    v_perm_b32 v146, v217, v209, s75
    v_perm_b32 v147, v217, v209, s76
    v_perm_b32 v148, v218, v210, s75
    v_perm_b32 v149, v218, v210, s76
    v_perm_b32 v150, v219, v211, s75
    v_perm_b32 v151, v219, v211, s76
    v_perm_b32 v152, v220, v212, s75
    v_perm_b32 v153, v220, v212, s76
    v_perm_b32 v154, v221, v213, s75
    v_perm_b32 v155, v221, v213, s76
    v_perm_b32 v156, v222, v214, s75
    v_perm_b32 v157, v222, v214, s76
    v_perm_b32 v158, v223, v215, s75
    v_perm_b32 v159, v223, v215, s76
    v_dot2c_f32_bf16 v224, v144, v19
    v_dot2c_f32_bf16 v225, v145, v19
    v_dot2c_f32_bf16 v226, v146, v19
    v_dot2c_f32_bf16 v227, v147, v19
    v_dot2c_f32_bf16 v228, v148, v19
    v_dot2c_f32_bf16 v229, v149, v19
    v_dot2c_f32_bf16 v230, v150, v19
    v_dot2c_f32_bf16 v231, v151, v19
    v_dot2c_f32_bf16 v232, v152, v19
    v_dot2c_f32_bf16 v233, v153, v19
    v_dot2c_f32_bf16 v234, v154, v19
    v_dot2c_f32_bf16 v235, v155, v19
    v_dot2c_f32_bf16 v236, v156, v19
    v_dot2c_f32_bf16 v237, v157, v19
    v_dot2c_f32_bf16 v238, v158, v19
    v_dot2c_f32_bf16 v239, v159, v19
    v_cvt_pk_bf16_f32 v136, v224, v225
    v_cvt_pk_bf16_f32 v137, v226, v227
    v_cvt_pk_bf16_f32 v138, v228, v229
    v_cvt_pk_bf16_f32 v139, v230, v231
    v_cvt_pk_bf16_f32 v140, v232, v233
    v_cvt_pk_bf16_f32 v141, v234, v235
    v_cvt_pk_bf16_f32 v142, v236, v237
    v_cvt_pk_bf16_f32 v143, v238, v239
    s_add_u32 s87, s71, 57344
    buffer_store_dwordx4 v[120:123], v6, s[16:19], s87 offen offset:0 sc1
    buffer_store_dwordx4 v[124:127], v6, s[16:19], s87 offen offset:2048 sc1
    s_add_u32 s87, s56, 57344
    buffer_store_dwordx4 v[136:139], v6, s[16:19], s87 offen offset:0 sc1
    buffer_store_dwordx4 v[140:143], v6, s[16:19], s87 offen offset:2048 sc1
    s_waitcnt vmcnt(0)
    v_mov_b32 v60, s88
    v_mov_b32 v61, s89
    v_mov_b32 v62, 0
    s_mov_b64 exec, 1
    buffer_store_dwordx2 v[60:61], v62, s[16:19], s6 offen offset:0 sc1
    s_mov_b64 exec, -1
    s_branch L_finA
L_B:
    s_setprio 0
    s_and_b32 s77, s2, 7
    s_lshl_b32 s77, s77, 2
    s_bfe_u32 s3, s2, 0x20003
    s_add_u32 s77, s77, s3
    s_lshr_b32 s78, s2, 5
    s_add_u32 s75, s77, s78
    s_and_b32 s75, s75, 3
    v_lshrrev_b32 v246, 2, v1
    v_xor_b32 v246, v246, v241
    v_and_b32 v246, 1, v246
    v_and_b32 v245, 3, v1
    v_lshlrev_b32 v8, 3, v245
    v_lshl_or_b32 v8, v249, 7, v8
    v_lshlrev_b32 v245, 4, v245
    v_lshl_or_b32 v246, v246, 6, v245
    s_lshl_b32 s70, s78, 7
    v_lshl_or_b32 v2, v240, 10, v246
    v_add_u32 v2, s70, v2
    s_mul_i32 s80, s55, 458752
    s_and_b32 s70, s77, 1
    s_lshl_b32 s70, s70, 16
    s_add_u32 s84, s80, s70
    s_sub_u32 s85, s80, s70
    s_lshl_b32 s81, s55, 17
    s_mul_i32 s82, s55, 12288
    s_add_u32 s82, s82, 40960
    s_bfe_u32 s69, s57, 0x10002
    s_lshl_b32 s69, s69, 1
    s_and_b32 s70, s57, 1
    s_add_u32 s69, s69, s70
    s_lshl_b32 s70, s69, 7
    s_add_u32 s70, s70, s72
    v_add_u32 v11, s70, v253
    s_lshl_b32 s68, s59, 3
    s_add_u32 s68, s68, s58
    s_lshl_b32 s68, s68, 13
    s_add_u32 s58, s68, 0x960000
    s_lshl_b32 s67, s69, 11
    s_bfe_u32 s68, s57, 0x10001
    s_lshl_b32 s68, s68, 3
    s_add_u32 s67, s67, s68
    s_lshr_b32 s68, s57, 3
    s_lshl_b32 s68, s68, 9
    s_add_u32 s67, s67, s68
    s_add_u32 s86, s67, s58
    s_lshl_b32 s67, s55, 11
    s_add_u32 s58, s58, s67
    s_lshl_b32 s83, s83, 4
    s_add_u32 s83, s83, 0x900000
    v_and_b32 v28, 31, v1
    v_lshlrev_b32 v29, 5, v28
    v_add_u32 v29, 131072, v29
    v_lshl_or_b32 v30, v250, 2, v29
    s_lshl_b32 s67, s55, 3
    v_add_u32 v30, s67, v30
    s_lshl_b32 s67, s55, 11
    s_add_u32 s67, s67, 131072
    v_add_u32 v31, s67, v6
    s_lshl_b32 s67, s57, 11
    s_lshl_b32 s68, s55, 9
    s_add_u32 s68, s68, s67
    s_max_u32 s67, s67, 256
    s_sub_u32 s67, s67, 256
    s_cmp_eq_u32 s59, 0
    s_cselect_b32 s67, s67, s68
    v_and_b32 v24, 15, v1
    v_lshl_add_u32 v25, v24, 4, s67
    v_lshl_add_u32 v23, v28, 4, s68
    v_cmp_gt_u32 vcc, 32, v1
    s_lshl_b32 s67, s55, 7
    s_add_u32 s67, s67, 131072
    v_cndmask_b32 v25, v25, v23, vcc
    v_lshl_add_u32 v26, v28, 2, s67
    v_lshlrev_b32 v24, 2, v24
    v_add_u32 v24, 131584, v24
    v_cndmask_b32 v26, v24, v26, vcc
    v_lshlrev_b32 v28, 4, v28
    v_lshl_or_b32 v28, v250, 10, v28
    v_lshlrev_b32 v29, 5, v1
    v_add_u32 v29, 131072, v29
    v_mov_b32 v20, 0
    v_mov_b32 v21, 0
    v_mov_b32 v12, v254
    v_lshl_add_u32 v243, v250, 4, v249
    v_lshl_add_u32 v242, v243, 7, v7
    v_lshrrev_b32 v243, 1, v249
    v_xor_b32 v243, s73, v243
    v_lshl_add_u32 v242, v243, 6, v242
    v_add_u32 v14, s82, v242
    v_xor_b32 v15, 64, v14
    s_lshl_b32 s69, s74, 10
    v_add_u32 v9, s69, v6
    v_xor_b32 v13, 0x400, v9
    s_mul_i32 s79, s77, 294912
    s_mul_i32 s69, s55, 73728
    s_add_u32 s79, s79, s69
    v_and_b32 v243, 31, v1
    v_lshlrev_b32 v243, 10, v243
    v_lshl_or_b32 v243, v250, 5, v243
    s_lshl_b32 s69, s77, 16
    s_lshl_b32 s68, s74, 15
    s_add_u32 s69, s69, s68
    s_lshl_b32 s68, s78, 7
    s_add_u32 s69, s69, s68
    s_lshl_b32 s67, s73, 6
    s_add_u32 s69, s69, s67
    v_add_u32 v0, s69, v243
    s_lshl_b32 s76, s77, 2
    s_add_u32 s76, s76, s55
    s_lshl_b32 s76, s76, 9
    s_add_u32 s76, s76, 0x910000
    v_mov_b32 v62, 131072
    v_mov_b32 v63, 1
    v_lshlrev_b32 v16, 2, v1
    v_add_u32 v27, 131072, v16
    v_mov_b32 v18, 0
    ds_write_b32 v27, v18 offset:32512
    s_waitcnt lgkmcnt(0)
    s_barrier
    s_bfe_u32 s1, s61, 0x40004
    s_lshl_b32 s0, s1, 7
    s_mul_i32 s1, s1, s63
    s_add_u32 m0, s66, 45056
    s_nop 0
    buffer_load_dwordx4 v3, s[8:11], s0 offen lds
    s_add_u32 m0, s72, 61440
    s_mov_b64 exec, s[64:65]
    buffer_load_dwordx4 v5, s[12:15], s1 offen lds
    s_mov_b64 exec, -1
    s_add_u32 s1, s1, s62
    s_add_u32 m0, s72, 62336
    s_mov_b64 exec, s[64:65]
    buffer_load_dwordx4 v5, s[12:15], s1 offen lds
    s_mov_b64 exec, -1
    s_add_u32 m0, s66, 46080
    s_nop 0
    buffer_load_dwordx4 v4, s[8:11], s0 offen lds
    s_barrier
    s_add_u32 s1, s1, s62
    s_add_u32 m0, s72, 63232
    s_mov_b64 exec, s[64:65]
    buffer_load_dwordx4 v5, s[12:15], s1 offen lds
    s_mov_b64 exec, -1
    ds_read_b64_tr_b16 v[44:45], v11 offset:0
    ds_read_b64_tr_b16 v[46:47], v11 offset:1792
    ds_read_b64_tr_b16 v[48:49], v11 offset:64
    ds_read_b64_tr_b16 v[50:51], v11 offset:1856
    s_add_u32 s1, s1, s62
    s_add_u32 m0, s72, 64128
    s_mov_b64 exec, s[64:65]
    buffer_load_dwordx4 v5, s[12:15], s1 offen lds
    s_mov_b64 exec, -1
    s_add_u32 s0, s0, 0x4000
    s_add_u32 m0, s66, 47104
    s_nop 0
    buffer_load_dwordx4 v3, s[8:11], s0 offen lds
    s_waitcnt lgkmcnt(0)
    s_add_u32 s1, s1, s62
    s_add_u32 m0, s72, 65024
    s_mov_b64 exec, s[64:65]
    buffer_load_dwordx4 v5, s[12:15], s1 offen lds
    s_mov_b64 exec, -1
    v_lshlrev_b32 v16, 16, v44
    v_and_b32 v17, 0xffff0000, v44
    v_add_f32 v16, v16, v17
    v_add_f32 v20, v20, v16
    s_add_u32 s1, s1, s62
    s_add_u32 m0, s72, 65920
    s_mov_b64 exec, s[64:65]
    buffer_load_dwordx4 v5, s[12:15], s1 offen lds
    s_mov_b64 exec, -1
    v_lshlrev_b32 v16, 16, v45
    v_and_b32 v17, 0xffff0000, v45
    v_add_f32 v16, v16, v17
    v_add_f32 v20, v20, v16
    s_add_u32 m0, s66, 48128
    s_nop 0
    buffer_load_dwordx4 v4, s[8:11], s0 offen lds
    v_lshlrev_b32 v16, 16, v46
    v_and_b32 v17, 0xffff0000, v46
    v_add_f32 v16, v16, v17
    v_add_f32 v20, v20, v16
    s_add_u32 s1, s1, s62
    s_add_u32 m0, s72, 66816
    s_mov_b64 exec, s[64:65]
    buffer_load_dwordx4 v5, s[12:15], s1 offen lds
    s_mov_b64 exec, -1
    v_lshlrev_b32 v16, 16, v47
    v_and_b32 v17, 0xffff0000, v47
    v_add_f32 v16, v16, v17
    v_add_f32 v20, v20, v16
    s_add_u32 s1, s1, s62
    s_add_u32 m0, s72, 67712
    s_mov_b64 exec, s[64:65]
    buffer_load_dwordx4 v5, s[12:15], s1 offen lds
    s_mov_b64 exec, -1
    v_lshlrev_b32 v16, 16, v48
    v_and_b32 v17, 0xffff0000, v48
    v_add_f32 v16, v16, v17
    v_add_f32 v21, v21, v16
    s_bfe_u32 s1, s61, 0x40008
    s_lshl_b32 s0, s1, 7
    s_mul_i32 s1, s1, s63
    s_add_u32 m0, s66, 90112
    s_nop 0
    buffer_load_dwordx4 v3, s[8:11], s0 offen lds
    v_lshlrev_b32 v16, 16, v49
    v_and_b32 v17, 0xffff0000, v49
    v_add_f32 v16, v16, v17
    v_add_f32 v21, v21, v16
    s_add_u32 m0, s72, 106496
    s_mov_b64 exec, s[64:65]
    buffer_load_dwordx4 v5, s[12:15], s1 offen lds
    s_mov_b64 exec, -1
    v_lshlrev_b32 v16, 16, v50
    v_and_b32 v17, 0xffff0000, v50
    v_add_f32 v16, v16, v17
    v_add_f32 v21, v21, v16
    s_add_u32 s1, s1, s62
    s_add_u32 m0, s72, 107392
    s_mov_b64 exec, s[64:65]
    buffer_load_dwordx4 v5, s[12:15], s1 offen lds
    s_mov_b64 exec, -1
    v_lshlrev_b32 v16, 16, v51
    v_and_b32 v17, 0xffff0000, v51
    v_add_f32 v16, v16, v17
    v_add_f32 v21, v21, v16
    s_add_u32 m0, s66, 91136
    s_nop 0
    buffer_load_dwordx4 v4, s[8:11], s0 offen lds
    s_add_u32 s1, s1, s62
    s_add_u32 m0, s72, 108288
    s_mov_b64 exec, s[64:65]
    buffer_load_dwordx4 v5, s[12:15], s1 offen lds
    s_mov_b64 exec, -1
    s_add_u32 s1, s1, s62
    s_add_u32 m0, s72, 109184
    s_mov_b64 exec, s[64:65]
    buffer_load_dwordx4 v5, s[12:15], s1 offen lds
    s_mov_b64 exec, -1
    s_cmp_eq_u32 s55, 0
    s_cbranch_scc0 B_t0
    v_mov_b32 v24, 0
    buffer_load_dwordx2 v[40:41], v24, s[32:35], 0 offen sc1
B_t0:
    s_waitcnt vmcnt(6)
    s_barrier
    s_add_u32 s0, s0, 0x4000
    s_add_u32 m0, s66, 92160
    s_nop 0
    buffer_load_dwordx4 v3, s[8:11], s0 offen lds
    ds_read_b64_tr_b16 v[44:45], v11 offset:45056
    ds_read_b64_tr_b16 v[46:47], v11 offset:46848
    ds_read_b64_tr_b16 v[48:49], v11 offset:45120
    ds_read_b64_tr_b16 v[50:51], v11 offset:46912
    s_add_u32 s1, s1, s62
    s_add_u32 m0, s72, 110080
    s_mov_b64 exec, s[64:65]
    buffer_load_dwordx4 v5, s[12:15], s1 offen lds
    s_mov_b64 exec, -1
    s_add_u32 s1, s1, s62
    s_add_u32 m0, s72, 110976
    s_mov_b64 exec, s[64:65]
    buffer_load_dwordx4 v5, s[12:15], s1 offen lds
    s_mov_b64 exec, -1
    s_waitcnt lgkmcnt(0)
    s_add_u32 m0, s66, 93184
    s_nop 0
    buffer_load_dwordx4 v4, s[8:11], s0 offen lds
    v_lshlrev_b32 v16, 16, v44
    v_and_b32 v17, 0xffff0000, v44
    v_add_f32 v16, v16, v17
    v_add_f32 v20, v20, v16
    s_add_u32 s1, s1, s62
    s_add_u32 m0, s72, 111872
    s_mov_b64 exec, s[64:65]
    buffer_load_dwordx4 v5, s[12:15], s1 offen lds
    s_mov_b64 exec, -1
    v_lshlrev_b32 v16, 16, v45
    v_and_b32 v17, 0xffff0000, v45
    v_add_f32 v16, v16, v17
    v_add_f32 v20, v20, v16
    s_add_u32 s1, s1, s62
    s_add_u32 m0, s72, 112768
    s_mov_b64 exec, s[64:65]
    buffer_load_dwordx4 v5, s[12:15], s1 offen lds
    s_mov_b64 exec, -1
    v_lshlrev_b32 v16, 16, v46
    v_and_b32 v17, 0xffff0000, v46
    v_add_f32 v16, v16, v17
    v_add_f32 v20, v20, v16
    s_bfe_u32 s1, s61, 0x4000c
    s_lshl_b32 s0, s1, 7
    s_mul_i32 s1, s1, s63
    s_add_u32 m0, s66, 0
    s_nop 0
    buffer_load_dwordx4 v3, s[8:11], s0 offen lds
    v_lshlrev_b32 v16, 16, v47
    v_and_b32 v17, 0xffff0000, v47
    v_add_f32 v16, v16, v17
    v_add_f32 v20, v20, v16
    s_add_u32 m0, s72, 16384
    s_mov_b64 exec, s[64:65]
    buffer_load_dwordx4 v5, s[12:15], s1 offen lds
    s_mov_b64 exec, -1
    v_lshlrev_b32 v16, 16, v48
    v_and_b32 v17, 0xffff0000, v48
    v_add_f32 v16, v16, v17
    v_add_f32 v21, v21, v16
    s_add_u32 s1, s1, s62
    s_add_u32 m0, s72, 17280
    s_mov_b64 exec, s[64:65]
    buffer_load_dwordx4 v5, s[12:15], s1 offen lds
    s_mov_b64 exec, -1
    v_lshlrev_b32 v16, 16, v49
    v_and_b32 v17, 0xffff0000, v49
    v_add_f32 v16, v16, v17
    v_add_f32 v21, v21, v16
    s_add_u32 m0, s66, 1024
    s_nop 0
    buffer_load_dwordx4 v4, s[8:11], s0 offen lds
    v_lshlrev_b32 v16, 16, v50
    v_and_b32 v17, 0xffff0000, v50
    v_add_f32 v16, v16, v17
    v_add_f32 v21, v21, v16
    s_add_u32 s1, s1, s62
    s_add_u32 m0, s72, 18176
    s_mov_b64 exec, s[64:65]
    buffer_load_dwordx4 v5, s[12:15], s1 offen lds
    s_mov_b64 exec, -1
    v_lshlrev_b32 v16, 16, v51
    v_and_b32 v17, 0xffff0000, v51
    v_add_f32 v16, v16, v17
    v_add_f32 v21, v21, v16
    s_add_u32 s1, s1, s62
    s_add_u32 m0, s72, 19072
    s_mov_b64 exec, s[64:65]
    buffer_load_dwordx4 v5, s[12:15], s1 offen lds
    s_mov_b64 exec, -1
    s_add_u32 s0, s0, 0x4000
    s_add_u32 m0, s66, 2048
    s_nop 0
    buffer_load_dwordx4 v3, s[8:11], s0 offen lds
    s_add_u32 s1, s1, s62
    s_add_u32 m0, s72, 19968
    s_mov_b64 exec, s[64:65]
    buffer_load_dwordx4 v5, s[12:15], s1 offen lds
    s_mov_b64 exec, -1
    s_add_u32 s1, s1, s62
    s_add_u32 m0, s72, 20864
    s_mov_b64 exec, s[64:65]
    buffer_load_dwordx4 v5, s[12:15], s1 offen lds
    s_mov_b64 exec, -1
    s_waitcnt vmcnt(9)
    s_barrier
    ds_write_b32 v30, v20 offset:4096
    ds_write_b32 v30, v21 offset:5120
    s_cmp_eq_u32 s55, 0
    s_cbranch_scc0 B_nnh
    s_mov_b32 s7, 0
B_nchk:
    v_readfirstlane_b32 s89, v41
    s_nop 0
    s_cmp_lg_u32 s89, 0
    s_cbranch_scc1 B_nok
    s_add_u32 s7, s7, 1
    s_cmp_ge_u32 s7, 20000
    s_cbranch_scc1 B_nok
    s_sleep 2
    v_mov_b32 v24, 0
    buffer_load_dwordx2 v[40:41], v24, s[32:35], 0 offen sc1
    s_waitcnt vmcnt(0)
    s_branch B_nchk
B_nok:
    ds_write_b64 v62, v[40:41] offset:31808
    v_mov_b32 v33, v40
    v_mov_b32 v34, v41
    v_mov_b32 v35, 0
B_nnh:
    s_add_u32 m0, s66, 3072
    s_nop 0
    buffer_load_dwordx4 v4, s[8:11], s0 offen lds
    s_add_u32 s1, s1, s62
    s_add_u32 m0, s72, 21760
    s_mov_b64 exec, s[64:65]
    buffer_load_dwordx4 v5, s[12:15], s1 offen lds
    s_mov_b64 exec, -1
    s_add_u32 s1, s1, s62
    s_add_u32 m0, s72, 22656
    s_mov_b64 exec, s[64:65]
    buffer_load_dwordx4 v5, s[12:15], s1 offen lds
    s_mov_b64 exec, -1
    s_bfe_u32 s1, s61, 0x40010
    s_lshl_b32 s0, s1, 7
    s_mul_i32 s1, s1, s63
    s_add_u32 m0, s66, 45056
    s_nop 0
    buffer_load_dwordx4 v3, s[8:11], s0 offen lds
    s_add_u32 m0, s72, 61440
    s_mov_b64 exec, s[64:65]
    buffer_load_dwordx4 v5, s[12:15], s1 offen lds
    s_mov_b64 exec, -1
    s_add_u32 s1, s1, s62
    s_add_u32 m0, s72, 62336
    s_mov_b64 exec, s[64:65]
    buffer_load_dwordx4 v5, s[12:15], s1 offen lds
    s_mov_b64 exec, -1
    s_add_u32 m0, s66, 46080
    s_nop 0
    buffer_load_dwordx4 v4, s[8:11], s0 offen lds
    s_add_u32 s1, s1, s62
    s_add_u32 m0, s72, 63232
    s_mov_b64 exec, s[64:65]
    buffer_load_dwordx4 v5, s[12:15], s1 offen lds
    s_mov_b64 exec, -1
    s_add_u32 s1, s1, s62
    s_add_u32 m0, s72, 64128
    s_mov_b64 exec, s[64:65]
    buffer_load_dwordx4 v5, s[12:15], s1 offen lds
    s_mov_b64 exec, -1
    s_add_u32 s0, s0, 0x4000
    s_add_u32 m0, s66, 47104
    s_nop 0
    buffer_load_dwordx4 v3, s[8:11], s0 offen lds
    s_add_u32 s1, s1, s62
    s_add_u32 m0, s72, 65024
    s_mov_b64 exec, s[64:65]
    buffer_load_dwordx4 v5, s[12:15], s1 offen lds
    s_mov_b64 exec, -1
    s_add_u32 s1, s1, s62
    s_add_u32 m0, s72, 65920
    s_mov_b64 exec, s[64:65]
    buffer_load_dwordx4 v5, s[12:15], s1 offen lds
    s_mov_b64 exec, -1
    s_add_u32 m0, s66, 48128
    s_nop 0
    buffer_load_dwordx4 v4, s[8:11], s0 offen lds
    s_add_u32 s1, s1, s62
    s_add_u32 m0, s72, 66816
    s_mov_b64 exec, s[64:65]
    buffer_load_dwordx4 v5, s[12:15], s1 offen lds
    s_mov_b64 exec, -1
    s_add_u32 s1, s1, s62
    s_add_u32 m0, s72, 67712
    s_mov_b64 exec, s[64:65]
    buffer_load_dwordx4 v5, s[12:15], s1 offen lds
    s_mov_b64 exec, -1
    s_waitcnt vmcnt(12)
    s_waitcnt lgkmcnt(0)
    s_barrier
    s_bfe_u32 s1, s61, 0x40014
    s_lshl_b32 s0, s1, 7
    s_mul_i32 s1, s1, s63
    s_add_u32 m0, s66, 90112
    s_nop 0
    buffer_load_dwordx4 v3, s[8:11], s0 offen lds
    ds_read_b32 v32, v27 offset:31744
    s_add_u32 m0, s72, 106496
    s_mov_b64 exec, s[64:65]
    buffer_load_dwordx4 v5, s[12:15], s1 offen lds
    s_mov_b64 exec, -1
    ds_read_b128 v[44:47], v29 offset:4096
    ds_read_b128 v[48:51], v29 offset:4112
    ds_read_b64 v[40:41], v62 offset:31808
    s_add_u32 s1, s1, s62
    s_add_u32 m0, s72, 107392
    s_mov_b64 exec, s[64:65]
    buffer_load_dwordx4 v5, s[12:15], s1 offen lds
    s_mov_b64 exec, -1
    s_nop 0
    s_add_u32 m0, s66, 91136
    s_nop 0
    buffer_load_dwordx4 v4, s[8:11], s0 offen lds
    s_waitcnt lgkmcnt(0)
    s_add_u32 s1, s1, s62
    s_add_u32 m0, s72, 108288
    s_mov_b64 exec, s[64:65]
    buffer_load_dwordx4 v5, s[12:15], s1 offen lds
    s_mov_b64 exec, -1
    v_add_f32 v44, v44, v45
    v_add_f32 v46, v46, v47
    v_add_f32 v48, v48, v49
    v_add_f32 v50, v50, v51
    s_add_u32 s1, s1, s62
    s_add_u32 m0, s72, 109184
    s_mov_b64 exec, s[64:65]
    buffer_load_dwordx4 v5, s[12:15], s1 offen lds
    s_mov_b64 exec, -1
    v_add_f32 v44, v44, v46
    v_add_f32 v48, v48, v50
    v_readfirstlane_b32 s88, v40
    v_add_f32 v44, v44, v48
    s_add_u32 s0, s0, 0x4000
    s_add_u32 m0, s66, 92160
    s_nop 0
    buffer_load_dwordx4 v3, s[8:11], s0 offen lds
    v_cvt_pk_bf16_f32 v46, v44, v44
    v_and_b32 v46, 0xffff0000, v46
    v_readfirstlane_b32 s89, v41
    v_sub_f32 v46, v44, v46
    s_add_u32 s1, s1, s62
    s_add_u32 m0, s72, 110080
    s_mov_b64 exec, s[64:65]
    buffer_load_dwordx4 v5, s[12:15], s1 offen lds
    s_mov_b64 exec, -1
    v_cvt_pk_bf16_f32 v44, v44, v46
    v_mov_b32 v45, v40
    s_cmp_eq_u32 s55, 1
    s_cbranch_scc0 B_npc
    buffer_store_dwordx2 v[44:45], v28, s[16:19], s86 offen sc1
B_npc:
    s_add_u32 s1, s1, s62
    s_add_u32 m0, s72, 110976
    s_mov_b64 exec, s[64:65]
    buffer_load_dwordx4 v5, s[12:15], s1 offen lds
    s_mov_b64 exec, -1
    s_cmp_eq_u32 s55, 0
    s_cbranch_scc0 B_npub
    s_mov_b64 exec, 0xff
    buffer_store_dwordx4 v[32:35], v6, s[16:19], s83 offen sc1
    s_mov_b64 exec, -1
B_npub:
    s_add_u32 m0, s66, 93184
    s_nop 0
    buffer_load_dwordx4 v4, s[8:11], s0 offen lds
    s_add_u32 s1, s1, s62
    s_add_u32 m0, s72, 111872
    s_mov_b64 exec, s[64:65]
    buffer_load_dwordx4 v5, s[12:15], s1 offen lds
    s_mov_b64 exec, -1
    s_add_u32 s1, s1, s62
    s_add_u32 m0, s72, 112768
    s_mov_b64 exec, s[64:65]
    buffer_load_dwordx4 v5, s[12:15], s1 offen lds
    s_mov_b64 exec, -1
    v_lshlrev_b32 v24, 7, v1
    s_cmp_eq_u32 s55, 1
    s_cbranch_scc0 B_t2
    s_mul_i32 s68, s2, 7168
    s_mov_b32 exec_hi, 0xffffff
    buffer_load_dword v22, v24, s[20:23], s68 offen
    s_branch B_t3
B_t2:
    s_cmp_eq_u32 s55, 2
    s_cbranch_scc0 B_t3
    s_lshl_b32 s67, s2, 11
    s_mov_b64 exec, 0xffff
    buffer_load_dword v22, v24, s[24:27], s67 offen
B_t3:
    s_mov_b64 exec, -1
    s_waitcnt vmcnt(12)
    s_barrier
    s_bfe_u32 s1, s61, 0x40018
    s_lshl_b32 s0, s1, 7
    s_mul_i32 s1, s1, s63
    s_add_u32 m0, s66, 0
    s_nop 0
    buffer_load_dwordx4 v3, s[8:11], s0 offen lds
    s_add_u32 m0, s72, 16384
    s_mov_b64 exec, s[64:65]
    buffer_load_dwordx4 v5, s[12:15], s1 offen lds
    s_mov_b64 exec, -1
    s_add_u32 s1, s1, s62
    s_add_u32 m0, s72, 17280
    s_mov_b64 exec, s[64:65]
    buffer_load_dwordx4 v5, s[12:15], s1 offen lds
    s_mov_b64 exec, -1
    s_add_u32 m0, s66, 1024
    s_nop 0
    buffer_load_dwordx4 v4, s[8:11], s0 offen lds
    s_add_u32 s1, s1, s62
    s_add_u32 m0, s72, 18176
    s_mov_b64 exec, s[64:65]
    buffer_load_dwordx4 v5, s[12:15], s1 offen lds
    s_mov_b64 exec, -1
    s_add_u32 s1, s1, s62
    s_add_u32 m0, s72, 19072
    s_mov_b64 exec, s[64:65]
    buffer_load_dwordx4 v5, s[12:15], s1 offen lds
    s_mov_b64 exec, -1
    s_add_u32 s0, s0, 0x4000
    s_add_u32 m0, s66, 2048
    s_nop 0
    buffer_load_dwordx4 v3, s[8:11], s0 offen lds
    s_add_u32 s1, s1, s62
    s_add_u32 m0, s72, 19968
    s_mov_b64 exec, s[64:65]
    buffer_load_dwordx4 v5, s[12:15], s1 offen lds
    s_mov_b64 exec, -1
    s_add_u32 s1, s1, s62
    s_add_u32 m0, s72, 20864
    s_mov_b64 exec, s[64:65]
    buffer_load_dwordx4 v5, s[12:15], s1 offen lds
    s_mov_b64 exec, -1
    s_add_u32 m0, s66, 3072
    s_nop 0
    buffer_load_dwordx4 v4, s[8:11], s0 offen lds
    s_add_u32 s1, s1, s62
    s_add_u32 m0, s72, 21760
    s_mov_b64 exec, s[64:65]
    buffer_load_dwordx4 v5, s[12:15], s1 offen lds
    s_mov_b64 exec, -1
    s_add_u32 s1, s1, s62
    s_add_u32 m0, s72, 22656
    s_mov_b64 exec, s[64:65]
    buffer_load_dwordx4 v5, s[12:15], s1 offen lds
    s_mov_b64 exec, -1
    s_mov_b32 s67, 0x900000
    buffer_load_dwordx4 v[32:35], v25, s[16:19], s67 offen sc1
    buffer_load_dwordx4 v[44:47], v6, s[16:19], s58 offen sc1
    buffer_load_dwordx4 v[48:51], v6, s[16:19], s58 offen offset:1024 sc1
    s_waitcnt vmcnt(15)
    s_barrier
    s_bfe_u32 s1, s61, 0x4001c
    s_lshl_b32 s0, s1, 7
    s_mul_i32 s1, s1, s63
    s_add_u32 m0, s66, 45056
    s_nop 0
    buffer_load_dwordx4 v3, s[8:11], s0 offen lds
    s_add_u32 m0, s72, 61440
    s_mov_b64 exec, s[64:65]
    buffer_load_dwordx4 v5, s[12:15], s1 offen lds
    s_mov_b64 exec, -1
    s_add_u32 s1, s1, s62
    s_add_u32 m0, s72, 62336
    s_mov_b64 exec, s[64:65]
    buffer_load_dwordx4 v5, s[12:15], s1 offen lds
    s_mov_b64 exec, -1
    s_add_u32 m0, s66, 46080
    s_nop 0
    buffer_load_dwordx4 v4, s[8:11], s0 offen lds
    s_add_u32 s1, s1, s62
    s_add_u32 m0, s72, 63232
    s_mov_b64 exec, s[64:65]
    buffer_load_dwordx4 v5, s[12:15], s1 offen lds
    s_mov_b64 exec, -1
    s_add_u32 s1, s1, s62
    s_add_u32 m0, s72, 64128
    s_mov_b64 exec, s[64:65]
    buffer_load_dwordx4 v5, s[12:15], s1 offen lds
    s_mov_b64 exec, -1
    s_add_u32 s0, s0, 0x4000
    s_add_u32 m0, s66, 47104
    s_nop 0
    buffer_load_dwordx4 v3, s[8:11], s0 offen lds
    s_add_u32 s1, s1, s62
    s_add_u32 m0, s72, 65024
    s_mov_b64 exec, s[64:65]
    buffer_load_dwordx4 v5, s[12:15], s1 offen lds
    s_mov_b64 exec, -1
    s_add_u32 s1, s1, s62
    s_add_u32 m0, s72, 65920
    s_mov_b64 exec, s[64:65]
    buffer_load_dwordx4 v5, s[12:15], s1 offen lds
    s_mov_b64 exec, -1
    s_add_u32 m0, s66, 48128
    s_nop 0
    buffer_load_dwordx4 v4, s[8:11], s0 offen lds
    s_add_u32 s1, s1, s62
    s_add_u32 m0, s72, 66816
    s_mov_b64 exec, s[64:65]
    buffer_load_dwordx4 v5, s[12:15], s1 offen lds
    s_mov_b64 exec, -1
    s_add_u32 s1, s1, s62
    s_add_u32 m0, s72, 67712
    s_mov_b64 exec, s[64:65]
    buffer_load_dwordx4 v5, s[12:15], s1 offen lds
    s_mov_b64 exec, -1
    s_waitcnt vmcnt(15)
    s_barrier
    s_waitcnt vmcnt(12)
    s_mov_b32 s7, 0
B_schk:
    v_cmp_ne_u32 vcc, s88, v33
    v_cmp_ne_u32 s[4:5], s89, v34
    s_nop 0
    s_or_b64 vcc, vcc, s[4:5]
    v_cmp_ne_u32 s[4:5], s88, v45
    s_nop 0
    s_or_b64 vcc, vcc, s[4:5]
    v_cmp_ne_u32 s[4:5], s88, v47
    s_nop 0
    s_or_b64 vcc, vcc, s[4:5]
    v_cmp_ne_u32 s[4:5], s88, v49
    s_nop 0
    s_or_b64 vcc, vcc, s[4:5]
    v_cmp_ne_u32 s[4:5], s88, v51
    s_nop 0
    s_or_b64 vcc, vcc, s[4:5]
    s_cbranch_scc0 B_sok
    s_add_u32 s7, s7, 1
    s_cmp_ge_u32 s7, 20000
    s_cbranch_scc1 B_sok
    s_sleep 2
    s_mov_b32 s67, 0x900000
    buffer_load_dwordx4 v[32:35], v25, s[16:19], s67 offen sc1
    buffer_load_dwordx4 v[44:47], v6, s[16:19], s58 offen sc1
    buffer_load_dwordx4 v[48:51], v6, s[16:19], s58 offen offset:1024 sc1
    s_waitcnt vmcnt(0)
    s_branch B_schk
B_sok:
    ds_write_b32 v26, v32 offset:31872
    v_mov_b32 v45, 0
    v_mov_b32 v47, 0
    v_mov_b32 v49, 0
    v_mov_b32 v51, 0
    ds_write_b128 v31, v[44:47] offset:24576
    s_cmp_eq_u32 s55, 3
    s_cbranch_scc1 B_nu7
    ds_write_b128 v31, v[48:51] offset:25600
B_nu7:
    s_add_u32 s0, s84, 65536
    s_add_u32 m0, s82, 49152
    s_nop 0
    buffer_load_dwordx4 v2, s[20:23], s0 offen lds
    s_add_u32 s0, s0, 8192
    s_add_u32 m0, s82, 50176
    s_nop 0
    buffer_load_dwordx4 v2, s[20:23], s0 offen lds
    s_add_u32 s0, s0, 8192
    s_add_u32 m0, s82, 51200
    s_nop 0
    buffer_load_dwordx4 v2, s[20:23], s0 offen lds
    s_add_u32 s0, s0, 8192
    s_add_u32 m0, s82, 52224
    s_nop 0
    buffer_load_dwordx4 v2, s[20:23], s0 offen lds
    s_add_u32 s0, s84, 98304
    s_add_u32 m0, s82, 53248
    s_nop 0
    buffer_load_dwordx4 v2, s[20:23], s0 offen lds
    s_add_u32 s0, s0, 8192
    s_add_u32 m0, s82, 54272
    s_nop 0
    buffer_load_dwordx4 v2, s[20:23], s0 offen lds
    s_add_u32 s0, s0, 8192
    s_add_u32 m0, s82, 55296
    s_nop 0
    buffer_load_dwordx4 v2, s[20:23], s0 offen lds
    s_add_u32 s0, s0, 8192
    s_add_u32 m0, s82, 56320
    s_nop 0
    buffer_load_dwordx4 v2, s[20:23], s0 offen lds
    s_add_u32 s0, s84, 294912
    s_add_u32 m0, s82, 57344
    s_nop 0
    buffer_load_dwordx4 v2, s[20:23], s0 offen lds
    s_add_u32 s0, s0, 8192
    s_add_u32 m0, s82, 58368
    s_nop 0
    buffer_load_dwordx4 v2, s[20:23], s0 offen lds
    s_add_u32 s0, s0, 8192
    s_add_u32 m0, s82, 59392
    s_nop 0
    buffer_load_dwordx4 v2, s[20:23], s0 offen lds
    s_add_u32 s0, s0, 8192
    s_add_u32 m0, s82, 60416
    s_nop 0
    buffer_load_dwordx4 v2, s[20:23], s0 offen lds
    s_waitcnt vmcnt(12)
    s_waitcnt lgkmcnt(0)
    s_barrier
    s_waitcnt vmcnt(8)
    ds_read_b64_tr_b16 v[64:65], v14 offset:49152
    ds_read_b64_tr_b16 v[66:67], v14 offset:49664
    ds_read_b64_tr_b16 v[68:69], v15 offset:49152
    ds_read_b64_tr_b16 v[70:71], v15 offset:49664
    ds_read_b64_tr_b16 v[72:73], v14 offset:50176
    ds_read_b64_tr_b16 v[74:75], v14 offset:50688
    ds_read_b64_tr_b16 v[76:77], v15 offset:50176
    ds_read_b64_tr_b16 v[78:79], v15 offset:50688
    s_waitcnt lgkmcnt(0)
    s_add_u32 s0, s84, 327680
    s_add_u32 m0, s82, 49152
    s_nop 0
    buffer_load_dwordx4 v2, s[20:23], s0 offen lds
    s_add_u32 s0, s0, 8192
    s_add_u32 m0, s82, 50176
    s_nop 0
    buffer_load_dwordx4 v2, s[20:23], s0 offen lds
    s_add_u32 s0, s0, 8192
    s_add_u32 m0, s82, 51200
    s_nop 0
    buffer_load_dwordx4 v2, s[20:23], s0 offen lds
    s_add_u32 s0, s0, 8192
    s_add_u32 m0, s82, 52224
    s_nop 0
    buffer_load_dwordx4 v2, s[20:23], s0 offen lds
    s_waitcnt vmcnt(8)
    ds_read_b64_tr_b16 v[80:81], v14 offset:53248
    ds_read_b64_tr_b16 v[82:83], v14 offset:53760
    ds_read_b64_tr_b16 v[84:85], v15 offset:53248
    ds_read_b64_tr_b16 v[86:87], v15 offset:53760
    ds_read_b64_tr_b16 v[88:89], v14 offset:54272
    ds_read_b64_tr_b16 v[90:91], v14 offset:54784
    ds_read_b64_tr_b16 v[92:93], v15 offset:54272
    ds_read_b64_tr_b16 v[94:95], v15 offset:54784
    s_waitcnt lgkmcnt(0)
    s_add_u32 s0, s85, 131072
    s_add_u32 m0, s82, 53248
    s_nop 0
    buffer_load_dwordx4 v2, s[20:23], s0 offen lds
    s_add_u32 s0, s0, 8192
    s_add_u32 m0, s82, 54272
    s_nop 0
    buffer_load_dwordx4 v2, s[20:23], s0 offen lds
    s_add_u32 s0, s0, 8192
    s_add_u32 m0, s82, 55296
    s_nop 0
    buffer_load_dwordx4 v2, s[20:23], s0 offen lds
    s_add_u32 s0, s0, 8192
    s_add_u32 m0, s82, 56320
    s_nop 0
    buffer_load_dwordx4 v2, s[20:23], s0 offen lds
    s_waitcnt vmcnt(8)
    ds_read_b64_tr_b16 v[96:97], v14 offset:57344
    ds_read_b64_tr_b16 v[98:99], v14 offset:57856
    ds_read_b64_tr_b16 v[100:101], v15 offset:57344
    ds_read_b64_tr_b16 v[102:103], v15 offset:57856
    ds_read_b64_tr_b16 v[104:105], v14 offset:58368
    ds_read_b64_tr_b16 v[106:107], v14 offset:58880
    ds_read_b64_tr_b16 v[108:109], v15 offset:58368
    ds_read_b64_tr_b16 v[110:111], v15 offset:58880
    s_waitcnt lgkmcnt(0)
    s_add_u32 s0, s85, 163840
    s_add_u32 m0, s82, 57344
    s_nop 0
    buffer_load_dwordx4 v2, s[20:23], s0 offen lds
    s_add_u32 s0, s0, 8192
    s_add_u32 m0, s82, 58368
    s_nop 0
    buffer_load_dwordx4 v2, s[20:23], s0 offen lds
    s_add_u32 s0, s0, 8192
    s_add_u32 m0, s82, 59392
    s_nop 0
    buffer_load_dwordx4 v2, s[20:23], s0 offen lds
    s_add_u32 s0, s0, 8192
    s_add_u32 m0, s82, 60416
    s_nop 0
    buffer_load_dwordx4 v2, s[20:23], s0 offen lds
    s_waitcnt vmcnt(8)
    ds_read_b64_tr_b16 v[112:113], v14 offset:49152
    ds_read_b64_tr_b16 v[114:115], v14 offset:49664
    ds_read_b64_tr_b16 v[116:117], v15 offset:49152
    ds_read_b64_tr_b16 v[118:119], v15 offset:49664
    ds_read_b64_tr_b16 v[120:121], v14 offset:50176
    ds_read_b64_tr_b16 v[122:123], v14 offset:50688
    ds_read_b64_tr_b16 v[124:125], v15 offset:50176
    ds_read_b64_tr_b16 v[126:127], v15 offset:50688
    s_waitcnt lgkmcnt(0)
    s_add_u32 s0, s85, 360448
    s_add_u32 m0, s82, 49152
    s_nop 0
    buffer_load_dwordx4 v2, s[20:23], s0 offen lds
    s_add_u32 s0, s0, 8192
    s_add_u32 m0, s82, 50176
    s_nop 0
    buffer_load_dwordx4 v2, s[20:23], s0 offen lds
    s_add_u32 s0, s0, 8192
    s_add_u32 m0, s82, 51200
    s_nop 0
    buffer_load_dwordx4 v2, s[20:23], s0 offen lds
    s_add_u32 s0, s0, 8192
    s_add_u32 m0, s82, 52224
    s_nop 0
    buffer_load_dwordx4 v2, s[20:23], s0 offen lds
    s_mov_b32 s7, 0
B_f9:
    ds_read_b32 v16, v62 offset:32544
    s_waitcnt lgkmcnt(0)
    v_readfirstlane_b32 s3, v16
    s_nop 0
    s_cmp_ge_u32 s3, 4
    s_cbranch_scc1 B_f9k
    s_add_u32 s7, s7, 1
    s_cmp_ge_u32 s7, 0x200000
    s_cbranch_scc1 B_f9k
    s_sleep 1
    s_nop 7
    s_branch B_f9
B_f9k:
    s_add_u32 s0, s85, 393216
    s_add_u32 m0, s82, 0
    s_nop 0
    buffer_load_dwordx4 v2, s[20:23], s0 offen lds
    s_add_u32 s0, s0, 8192
    s_add_u32 m0, s82, 1024
    s_nop 0
    buffer_load_dwordx4 v2, s[20:23], s0 offen lds
    s_add_u32 s0, s0, 8192
    s_add_u32 m0, s82, 2048
    s_nop 0
    buffer_load_dwordx4 v2, s[20:23], s0 offen lds
    s_add_u32 s0, s0, 8192
    s_add_u32 m0, s82, 3072
    s_nop 0
    buffer_load_dwordx4 v2, s[20:23], s0 offen lds
    s_add_u32 s0, s80, 0
    s_add_u32 m0, s82, 4096
    s_nop 0
    buffer_load_dwordx4 v2, s[20:23], s0 offen lds
    s_add_u32 s0, s0, 8192
    s_add_u32 m0, s82, 5120
    s_nop 0
    buffer_load_dwordx4 v2, s[20:23], s0 offen lds
    s_add_u32 s0, s0, 8192
    s_add_u32 m0, s82, 6144
    s_nop 0
    buffer_load_dwordx4 v2, s[20:23], s0 offen lds
    s_add_u32 s0, s0, 8192
    s_add_u32 m0, s82, 7168
    s_nop 0
    buffer_load_dwordx4 v2, s[20:23], s0 offen lds
    s_add_u32 s0, s80, 32768
    s_add_u32 m0, s82, 8192
    s_nop 0
    buffer_load_dwordx4 v2, s[20:23], s0 offen lds
    s_add_u32 s0, s0, 8192
    s_add_u32 m0, s82, 9216
    s_nop 0
    buffer_load_dwordx4 v2, s[20:23], s0 offen lds
    s_add_u32 s0, s0, 8192
    s_add_u32 m0, s82, 10240
    s_nop 0
    buffer_load_dwordx4 v2, s[20:23], s0 offen lds
    s_add_u32 s0, s0, 8192
    s_add_u32 m0, s82, 11264
    s_nop 0
    buffer_load_dwordx4 v2, s[20:23], s0 offen lds
    s_waitcnt vmcnt(20)
    ds_read_b64_tr_b16 v[128:129], v14 offset:53248
    ds_read_b64_tr_b16 v[130:131], v14 offset:53760
    ds_read_b64_tr_b16 v[132:133], v15 offset:53248
    ds_read_b64_tr_b16 v[134:135], v15 offset:53760
    ds_read_b64_tr_b16 v[136:137], v14 offset:54272
    ds_read_b64_tr_b16 v[138:139], v14 offset:54784
    ds_read_b64_tr_b16 v[140:141], v15 offset:54272
    ds_read_b64_tr_b16 v[142:143], v15 offset:54784
    s_waitcnt vmcnt(16)
    ds_read_b64_tr_b16 v[144:145], v14 offset:57344
    ds_read_b64_tr_b16 v[146:147], v14 offset:57856
    ds_read_b64_tr_b16 v[148:149], v15 offset:57344
    ds_read_b64_tr_b16 v[150:151], v15 offset:57856
    ds_read_b64_tr_b16 v[152:153], v14 offset:58368
    ds_read_b64_tr_b16 v[154:155], v14 offset:58880
    ds_read_b64_tr_b16 v[156:157], v15 offset:58368
    ds_read_b64_tr_b16 v[158:159], v15 offset:58880
    s_waitcnt vmcnt(12)
    ds_read_b64_tr_b16 v[160:161], v14 offset:49152
    ds_read_b64_tr_b16 v[162:163], v14 offset:49664
    ds_read_b64_tr_b16 v[164:165], v15 offset:49152
    ds_read_b64_tr_b16 v[166:167], v15 offset:49664
    ds_read_b64_tr_b16 v[168:169], v14 offset:50176
    ds_read_b64_tr_b16 v[170:171], v14 offset:50688
    ds_read_b64_tr_b16 v[172:173], v15 offset:50176
    ds_read_b64_tr_b16 v[174:175], v15 offset:50688
    s_waitcnt vmcnt(8)
    ds_read_b64_tr_b16 v[176:177], v14 offset:0
    ds_read_b64_tr_b16 v[178:179], v14 offset:512
    ds_read_b64_tr_b16 v[180:181], v15 offset:0
    ds_read_b64_tr_b16 v[182:183], v15 offset:512
    ds_read_b64_tr_b16 v[184:185], v14 offset:1024
    ds_read_b64_tr_b16 v[186:187], v14 offset:1536
    ds_read_b64_tr_b16 v[188:189], v15 offset:1024
    ds_read_b64_tr_b16 v[190:191], v15 offset:1536
    s_waitcnt lgkmcnt(15)
    s_waitcnt lgkmcnt(8)
    s_waitcnt lgkmcnt(0)
    s_cmp_eq_u32 s59, 0
    s_cbranch_scc1 B_qk
    s_mov_b32 s7, 0
B_q:
    ds_read_b32 v16, v62 offset:32584
    s_waitcnt lgkmcnt(0)
    v_readfirstlane_b32 s3, v16
    s_nop 0
    s_cmp_ge_u32 s3, 4
    s_cbranch_scc1 B_qk
    s_add_u32 s7, s7, 1
    s_cmp_ge_u32 s7, 0x200000
    s_cbranch_scc1 B_qk
    s_sleep 1
    s_nop 7
    s_branch B_q
B_qk:
    s_add_u32 s0, s80, 229376
    s_add_u32 m0, s82, 53248
    s_nop 0
    buffer_load_dwordx4 v2, s[20:23], s0 offen lds
    s_add_u32 s0, s0, 8192
    s_add_u32 m0, s82, 54272
    s_nop 0
    buffer_load_dwordx4 v2, s[20:23], s0 offen lds
    s_add_u32 s0, s0, 8192
    s_add_u32 m0, s82, 55296
    s_nop 0
    buffer_load_dwordx4 v2, s[20:23], s0 offen lds
    s_add_u32 s0, s0, 8192
    s_add_u32 m0, s82, 56320
    s_nop 0
    buffer_load_dwordx4 v2, s[20:23], s0 offen lds
    s_add_u32 s0, s80, 262144
    s_add_u32 m0, s82, 57344
    s_nop 0
    buffer_load_dwordx4 v2, s[20:23], s0 offen lds
    s_add_u32 s0, s0, 8192
    s_add_u32 m0, s82, 58368
    s_nop 0
    buffer_load_dwordx4 v2, s[20:23], s0 offen lds
    s_add_u32 s0, s0, 8192
    s_add_u32 m0, s82, 59392
    s_nop 0
    buffer_load_dwordx4 v2, s[20:23], s0 offen lds
    s_add_u32 s0, s0, 8192
    s_add_u32 m0, s82, 60416
    s_nop 0
    buffer_load_dwordx4 v2, s[20:23], s0 offen lds
    s_mov_b32 s69, 0
    s_andn2_b32 s3, 0xf0, s69
    s_cbranch_scc0 P2p0
    v_mov_b32 v10, 0
    v_mov_b32 v11, 0
    s_mov_b64 exec, 0xffff
    buffer_atomic_or_x2 v[10:11], v8, s[16:19], s76 offen sc0 sc1
    s_mov_b64 exec, -1
P2p0:
    s_add_u32 s0, s80, 196608
    s_add_u32 m0, s82, 49152
    s_nop 0
    buffer_load_dwordx4 v2, s[20:23], s0 offen lds
    s_add_u32 s0, s0, 8192
    s_add_u32 m0, s82, 50176
    s_nop 0
    buffer_load_dwordx4 v2, s[20:23], s0 offen lds
    s_add_u32 s0, s0, 8192
    s_add_u32 m0, s82, 51200
    s_nop 0
    buffer_load_dwordx4 v2, s[20:23], s0 offen lds
    s_add_u32 s0, s0, 8192
    s_add_u32 m0, s82, 52224
    s_nop 0
    buffer_load_dwordx4 v2, s[20:23], s0 offen lds
    s_add_u32 s0, s80, 425984
    s_add_u32 m0, s82, 0
    s_nop 0
    buffer_load_dwordx4 v2, s[20:23], s0 offen lds
    s_add_u32 s0, s0, 8192
    s_add_u32 m0, s82, 1024
    s_nop 0
    buffer_load_dwordx4 v2, s[20:23], s0 offen lds
    s_add_u32 s0, s0, 8192
    s_add_u32 m0, s82, 2048
    s_nop 0
    buffer_load_dwordx4 v2, s[20:23], s0 offen lds
    s_add_u32 s0, s0, 8192
    s_add_u32 m0, s82, 3072
    s_nop 0
    buffer_load_dwordx4 v2, s[20:23], s0 offen lds
    s_andn2_b32 s3, 0xf0, s69
    s_cbranch_scc0 P2k0
    s_waitcnt vmcnt(8)
    s_mov_b32 s7, 0
P2c0:
    v_cmp_eq_u32 vcc, s88, v10
    v_cmp_eq_u32 s[4:5], s89, v11
    s_nop 0
    s_and_b32 s69, vcc_lo, s4
    s_andn2_b32 s3, 0xf0, s69
    s_cbranch_scc0 P2k0
    s_add_u32 s7, s7, 1
    s_cmp_ge_u32 s7, 20000
    s_cbranch_scc1 P2k0
    s_sleep 1
    s_nop 7
    v_mov_b32 v10, 0
    v_mov_b32 v11, 0
    s_mov_b64 exec, 0xffff
    buffer_atomic_or_x2 v[10:11], v8, s[16:19], s76 offen sc0 sc1
    s_mov_b64 exec, -1
    s_waitcnt vmcnt(0)
    s_branch P2c0
P2k0:
    s_add_u32 s68, s79, 0
    buffer_load_dwordx4 v[16:19], v9, s[16:19], s68 offen offset:0 sc1
    buffer_load_dwordx4 v[20:23], v13, s[16:19], s68 offen offset:0 sc1
    buffer_load_dwordx4 v[24:27], v9, s[16:19], s68 offen offset:2048 sc1
    buffer_load_dwordx4 v[28:31], v13, s[16:19], s68 offen offset:2048 sc1
    s_add_u32 s68, s79, 4096
    buffer_load_dwordx4 v[32:35], v9, s[16:19], s68 offen offset:0 sc1
    buffer_load_dwordx4 v[36:39], v13, s[16:19], s68 offen offset:0 sc1
    buffer_load_dwordx4 v[40:43], v9, s[16:19], s68 offen offset:2048 sc1
    buffer_load_dwordx4 v[44:47], v13, s[16:19], s68 offen offset:2048 sc1
    s_add_u32 s68, s79, 8192
    buffer_load_dwordx4 v[48:51], v9, s[16:19], s68 offen offset:0 sc1
    buffer_load_dwordx4 v[52:55], v13, s[16:19], s68 offen offset:0 sc1
    buffer_load_dwordx4 v[56:59], v9, s[16:19], s68 offen offset:2048 sc1
    buffer_load_dwordx4 v[60:63], v13, s[16:19], s68 offen offset:2048 sc1
    s_andn2_b32 s3, 0xf00, s69
    s_cbranch_scc0 P2p4
    v_mov_b32 v10, 0
    v_mov_b32 v11, 0
    s_mov_b64 exec, 0xffff
    buffer_atomic_or_x2 v[10:11], v8, s[16:19], s76 offen sc0 sc1
    s_mov_b64 exec, -1
P2p4:
    s_waitcnt vmcnt(11)
    v_mfma_f32_32x32x16_bf16 v[192:207], v[64:67], v[16:19], 0
    s_waitcnt vmcnt(10)
    v_mfma_f32_32x32x16_bf16 v[208:223], v[64:67], v[20:23], 0
    v_mfma_f32_32x32x16_bf16 v[224:239], v[68:71], v[16:19], 0
    v_mfma_f32_32x32x16_bf16 v[240:255], v[68:71], v[20:23], 0
    s_waitcnt vmcnt(9)
    v_mfma_f32_32x32x16_bf16 v[192:207], v[72:75], v[24:27], v[192:207]
    s_add_u32 s68, s79, 12288
    buffer_load_dwordx4 v[16:19], v9, s[16:19], s68 offen offset:0 sc1
    s_waitcnt vmcnt(9)
    v_mfma_f32_32x32x16_bf16 v[208:223], v[72:75], v[28:31], v[208:223]
    buffer_load_dwordx4 v[20:23], v13, s[16:19], s68 offen offset:0 sc1
    v_mfma_f32_32x32x16_bf16 v[224:239], v[76:79], v[24:27], v[224:239]
    v_mfma_f32_32x32x16_bf16 v[240:255], v[76:79], v[28:31], v[240:255]
    s_waitcnt vmcnt(9)
    v_mfma_f32_32x32x16_bf16 v[192:207], v[80:83], v[32:35], v[192:207]
    buffer_load_dwordx4 v[24:27], v9, s[16:19], s68 offen offset:2048 sc1
    s_waitcnt vmcnt(9)
    v_mfma_f32_32x32x16_bf16 v[208:223], v[80:83], v[36:39], v[208:223]
    buffer_load_dwordx4 v[28:31], v13, s[16:19], s68 offen offset:2048 sc1
    v_mfma_f32_32x32x16_bf16 v[224:239], v[84:87], v[32:35], v[224:239]
    v_mfma_f32_32x32x16_bf16 v[240:255], v[84:87], v[36:39], v[240:255]
    s_waitcnt vmcnt(9)
    v_mfma_f32_32x32x16_bf16 v[192:207], v[88:91], v[40:43], v[192:207]
    ds_read_b64_tr_b16 v[64:65], v14 offset:4096
    ds_read_b64_tr_b16 v[66:67], v14 offset:4608
    s_andn2_b32 s3, 0xf00, s69
    s_cbranch_scc0 P2k4
    s_waitcnt vmcnt(4)
    s_mov_b32 s7, 0
P2c4:
    v_cmp_eq_u32 vcc, s88, v10
    v_cmp_eq_u32 s[4:5], s89, v11
    s_nop 0
    s_and_b32 s69, vcc_lo, s4
    s_andn2_b32 s3, 0xf00, s69
    s_cbranch_scc0 P2k4
    s_add_u32 s7, s7, 1
    s_cmp_ge_u32 s7, 20000
    s_cbranch_scc1 P2k4
    s_sleep 1
    s_nop 7
    v_mov_b32 v10, 0
    v_mov_b32 v11, 0
    s_mov_b64 exec, 0xffff
    buffer_atomic_or_x2 v[10:11], v8, s[16:19], s76 offen sc0 sc1
    s_mov_b64 exec, -1
    s_waitcnt vmcnt(0)
    s_branch P2c4
P2k4:
    s_add_u32 s68, s79, 16384
    buffer_load_dwordx4 v[32:35], v9, s[16:19], s68 offen offset:0 sc1
    s_waitcnt vmcnt(9)
    v_mfma_f32_32x32x16_bf16 v[208:223], v[88:91], v[44:47], v[208:223]
    ds_read_b64_tr_b16 v[68:69], v15 offset:4096
    ds_read_b64_tr_b16 v[70:71], v15 offset:4608
    buffer_load_dwordx4 v[36:39], v13, s[16:19], s68 offen offset:0 sc1
    v_mfma_f32_32x32x16_bf16 v[224:239], v[92:95], v[40:43], v[224:239]
    ds_read_b64_tr_b16 v[72:73], v14 offset:5120
    ds_read_b64_tr_b16 v[74:75], v14 offset:5632
    v_mfma_f32_32x32x16_bf16 v[240:255], v[92:95], v[44:47], v[240:255]
    ds_read_b64_tr_b16 v[76:77], v15 offset:5120
    ds_read_b64_tr_b16 v[78:79], v15 offset:5632
    s_waitcnt vmcnt(9)
    v_mfma_f32_32x32x16_bf16 v[192:207], v[96:99], v[48:51], v[192:207]
    buffer_load_dwordx4 v[40:43], v9, s[16:19], s68 offen offset:2048 sc1
    s_waitcnt lgkmcnt(0)
    s_add_u32 s0, s81, 0
    s_add_u32 m0, s82, 4096
    s_nop 0
    buffer_load_dwordx4 v2, s[24:27], s0 offen lds
    s_waitcnt vmcnt(10)
    v_mfma_f32_32x32x16_bf16 v[208:223], v[96:99], v[52:55], v[208:223]
    buffer_load_dwordx4 v[44:47], v13, s[16:19], s68 offen offset:2048 sc1
    s_add_u32 s0, s0, 8192
    s_add_u32 m0, s82, 5120
    s_nop 0
    buffer_load_dwordx4 v2, s[24:27], s0 offen lds
    v_mfma_f32_32x32x16_bf16 v[224:239], v[100:103], v[48:51], v[224:239]
    s_add_u32 s0, s0, 8192
    s_add_u32 m0, s82, 6144
    s_nop 0
    buffer_load_dwordx4 v2, s[24:27], s0 offen lds
    v_mfma_f32_32x32x16_bf16 v[240:255], v[100:103], v[52:55], v[240:255]
    s_add_u32 s0, s0, 8192
    s_add_u32 m0, s82, 7168
    s_nop 0
    buffer_load_dwordx4 v2, s[24:27], s0 offen lds
    s_waitcnt vmcnt(13)
    v_mfma_f32_32x32x16_bf16 v[192:207], v[104:107], v[56:59], v[192:207]
    ds_read_b64_tr_b16 v[80:81], v14 offset:8192
    ds_read_b64_tr_b16 v[82:83], v14 offset:8704
    s_add_u32 s68, s79, 20480
    buffer_load_dwordx4 v[48:51], v9, s[16:19], s68 offen offset:0 sc1
    s_waitcnt vmcnt(13)
    v_mfma_f32_32x32x16_bf16 v[208:223], v[104:107], v[60:63], v[208:223]
    ds_read_b64_tr_b16 v[84:85], v15 offset:8192
    ds_read_b64_tr_b16 v[86:87], v15 offset:8704
    buffer_load_dwordx4 v[52:55], v13, s[16:19], s68 offen offset:0 sc1
    v_mfma_f32_32x32x16_bf16 v[224:239], v[108:111], v[56:59], v[224:239]
    ds_read_b64_tr_b16 v[88:89], v14 offset:9216
    ds_read_b64_tr_b16 v[90:91], v14 offset:9728
    v_mfma_f32_32x32x16_bf16 v[240:255], v[108:111], v[60:63], v[240:255]
    ds_read_b64_tr_b16 v[92:93], v15 offset:9216
    ds_read_b64_tr_b16 v[94:95], v15 offset:9728
    s_waitcnt vmcnt(13)
    v_mfma_f32_32x32x16_bf16 v[192:207], v[112:115], v[16:19], v[192:207]
    buffer_load_dwordx4 v[56:59], v9, s[16:19], s68 offen offset:2048 sc1
    s_waitcnt lgkmcnt(0)
    s_add_u32 s0, s81, 32768
    s_add_u32 m0, s82, 8192
    s_nop 0
    buffer_load_dwordx4 v2, s[24:27], s0 offen lds
    s_waitcnt vmcnt(14)
    v_mfma_f32_32x32x16_bf16 v[208:223], v[112:115], v[20:23], v[208:223]
    buffer_load_dwordx4 v[60:63], v13, s[16:19], s68 offen offset:2048 sc1
    s_add_u32 s0, s0, 8192
    s_add_u32 m0, s82, 9216
    s_nop 0
    buffer_load_dwordx4 v2, s[24:27], s0 offen lds
    v_mfma_f32_32x32x16_bf16 v[224:239], v[116:119], v[16:19], v[224:239]
    s_add_u32 s0, s0, 8192
    s_add_u32 m0, s82, 10240
    s_nop 0
    buffer_load_dwordx4 v2, s[24:27], s0 offen lds
    v_mfma_f32_32x32x16_bf16 v[240:255], v[116:119], v[20:23], v[240:255]
    s_add_u32 s0, s0, 8192
    s_add_u32 m0, s82, 11264
    s_nop 0
    buffer_load_dwordx4 v2, s[24:27], s0 offen lds
    s_waitcnt vmcnt(17)
    v_mfma_f32_32x32x16_bf16 v[192:207], v[120:123], v[24:27], v[192:207]
    ds_read_b64_tr_b16 v[96:97], v14 offset:53248
    ds_read_b64_tr_b16 v[98:99], v14 offset:53760
    s_add_u32 s68, s79, 24576
    buffer_load_dwordx4 v[16:19], v9, s[16:19], s68 offen offset:0 sc1
    s_waitcnt vmcnt(17)
    v_mfma_f32_32x32x16_bf16 v[208:223], v[120:123], v[28:31], v[208:223]
    ds_read_b64_tr_b16 v[100:101], v15 offset:53248
    ds_read_b64_tr_b16 v[102:103], v15 offset:53760
    buffer_load_dwordx4 v[20:23], v13, s[16:19], s68 offen offset:0 sc1
    v_mfma_f32_32x32x16_bf16 v[224:239], v[124:127], v[24:27], v[224:239]
    ds_read_b64_tr_b16 v[104:105], v14 offset:54272
    ds_read_b64_tr_b16 v[106:107], v14 offset:54784
    v_mfma_f32_32x32x16_bf16 v[240:255], v[124:127], v[28:31], v[240:255]
    ds_read_b64_tr_b16 v[108:109], v15 offset:54272
    ds_read_b64_tr_b16 v[110:111], v15 offset:54784
    s_andn2_b32 s3, 0xf000, s69
    s_cbranch_scc0 P2p8
    v_mov_b32 v10, 0
    v_mov_b32 v11, 0
    s_mov_b64 exec, 0xffff
    buffer_atomic_or_x2 v[10:11], v8, s[16:19], s76 offen sc0 sc1
    s_mov_b64 exec, -1
P2p8:
    s_waitcnt vmcnt(17)
    v_mfma_f32_32x32x16_bf16 v[192:207], v[128:131], v[32:35], v[192:207]
    buffer_load_dwordx4 v[24:27], v9, s[16:19], s68 offen offset:2048 sc1
    s_waitcnt lgkmcnt(0)
    s_add_u32 s0, s81, 65536
    s_add_u32 m0, s82, 53248
    s_nop 0
    buffer_load_dwordx4 v2, s[24:27], s0 offen lds
    s_waitcnt vmcnt(18)
    v_mfma_f32_32x32x16_bf16 v[208:223], v[128:131], v[36:39], v[208:223]
    buffer_load_dwordx4 v[28:31], v13, s[16:19], s68 offen offset:2048 sc1
    s_add_u32 s0, s0, 8192
    s_add_u32 m0, s82, 54272
    s_nop 0
    buffer_load_dwordx4 v2, s[24:27], s0 offen lds
    v_mfma_f32_32x32x16_bf16 v[224:239], v[132:135], v[32:35], v[224:239]
    s_add_u32 s0, s0, 8192
    s_add_u32 m0, s82, 55296
    s_nop 0
    buffer_load_dwordx4 v2, s[24:27], s0 offen lds
    v_mfma_f32_32x32x16_bf16 v[240:255], v[132:135], v[36:39], v[240:255]
    s_add_u32 s0, s0, 8192
    s_add_u32 m0, s82, 56320
    s_nop 0
    buffer_load_dwordx4 v2, s[24:27], s0 offen lds
    s_waitcnt vmcnt(21)
    v_mfma_f32_32x32x16_bf16 v[192:207], v[136:139], v[40:43], v[192:207]
    ds_read_b64_tr_b16 v[112:113], v14 offset:57344
    ds_read_b64_tr_b16 v[114:115], v14 offset:57856
    s_add_u32 s68, s79, 28672
    buffer_load_dwordx4 v[32:35], v9, s[16:19], s68 offen offset:0 sc1
    s_waitcnt vmcnt(20)
    v_mfma_f32_32x32x16_bf16 v[208:223], v[136:139], v[44:47], v[208:223]
    ds_read_b64_tr_b16 v[116:117], v15 offset:57344
    ds_read_b64_tr_b16 v[118:119], v15 offset:57856
    buffer_load_dwordx4 v[36:39], v13, s[16:19], s68 offen offset:0 sc1
    v_mfma_f32_32x32x16_bf16 v[224:239], v[140:143], v[40:43], v[224:239]
    ds_read_b64_tr_b16 v[120:121], v14 offset:58368
    ds_read_b64_tr_b16 v[122:123], v14 offset:58880
    v_mfma_f32_32x32x16_bf16 v[240:255], v[140:143], v[44:47], v[240:255]
    ds_read_b64_tr_b16 v[124:125], v15 offset:58368
    ds_read_b64_tr_b16 v[126:127], v15 offset:58880
    s_waitcnt vmcnt(17)
    v_mfma_f32_32x32x16_bf16 v[192:207], v[144:147], v[48:51], v[192:207]
    buffer_load_dwordx4 v[40:43], v9, s[16:19], s68 offen offset:2048 sc1
    s_waitcnt lgkmcnt(0)
    s_add_u32 s0, s81, 98304
    s_add_u32 m0, s82, 57344
    s_nop 0
    buffer_load_dwordx4 v2, s[24:27], s0 offen lds
    s_waitcnt vmcnt(18)
    v_mfma_f32_32x32x16_bf16 v[208:223], v[144:147], v[52:55], v[208:223]
    buffer_load_dwordx4 v[44:47], v13, s[16:19], s68 offen offset:2048 sc1
    s_add_u32 s0, s0, 8192
    s_add_u32 m0, s82, 58368
    s_nop 0
    buffer_load_dwordx4 v2, s[24:27], s0 offen lds
    v_mfma_f32_32x32x16_bf16 v[224:239], v[148:151], v[48:51], v[224:239]
    s_add_u32 s0, s0, 8192
    s_add_u32 m0, s82, 59392
    s_nop 0
    buffer_load_dwordx4 v2, s[24:27], s0 offen lds
    v_mfma_f32_32x32x16_bf16 v[240:255], v[148:151], v[52:55], v[240:255]
    s_add_u32 s0, s0, 8192
    s_add_u32 m0, s82, 60416
    s_nop 0
    buffer_load_dwordx4 v2, s[24:27], s0 offen lds
    s_waitcnt vmcnt(21)
    v_mfma_f32_32x32x16_bf16 v[192:207], v[152:155], v[56:59], v[192:207]
    ds_read_b64_tr_b16 v[128:129], v14 offset:49152
    ds_read_b64_tr_b16 v[130:131], v14 offset:49664
    s_andn2_b32 s3, 0xf000, s69
    s_cbranch_scc0 P2k8
    s_waitcnt vmcnt(14)
    s_mov_b32 s7, 0
P2c8:
    v_cmp_eq_u32 vcc, s88, v10
    v_cmp_eq_u32 s[4:5], s89, v11
    s_nop 0
    s_and_b32 s69, vcc_lo, s4
    s_andn2_b32 s3, 0xf000, s69
    s_cbranch_scc0 P2k8
    s_add_u32 s7, s7, 1
    s_cmp_ge_u32 s7, 20000
    s_cbranch_scc1 P2k8
    s_sleep 1
    s_nop 7
    v_mov_b32 v10, 0
    v_mov_b32 v11, 0
    s_mov_b64 exec, 0xffff
    buffer_atomic_or_x2 v[10:11], v8, s[16:19], s76 offen sc0 sc1
    s_mov_b64 exec, -1
    s_waitcnt vmcnt(0)
    s_branch P2c8
P2k8:
    s_add_u32 s68, s79, 32768
    buffer_load_dwordx4 v[48:51], v9, s[16:19], s68 offen offset:0 sc1
    s_waitcnt vmcnt(20)
    v_mfma_f32_32x32x16_bf16 v[208:223], v[152:155], v[60:63], v[208:223]
    ds_read_b64_tr_b16 v[132:133], v15 offset:49152
    ds_read_b64_tr_b16 v[134:135], v15 offset:49664
    buffer_load_dwordx4 v[52:55], v13, s[16:19], s68 offen offset:0 sc1
    v_mfma_f32_32x32x16_bf16 v[224:239], v[156:159], v[56:59], v[224:239]
    ds_read_b64_tr_b16 v[136:137], v14 offset:50176
    ds_read_b64_tr_b16 v[138:139], v14 offset:50688
    v_mfma_f32_32x32x16_bf16 v[240:255], v[156:159], v[60:63], v[240:255]
    ds_read_b64_tr_b16 v[140:141], v15 offset:50176
    ds_read_b64_tr_b16 v[142:143], v15 offset:50688
    s_waitcnt vmcnt(17)
    v_mfma_f32_32x32x16_bf16 v[192:207], v[160:163], v[16:19], v[192:207]
    buffer_load_dwordx4 v[56:59], v9, s[16:19], s68 offen offset:2048 sc1
    s_waitcnt lgkmcnt(0)
    s_waitcnt vmcnt(17)
    v_mfma_f32_32x32x16_bf16 v[208:223], v[160:163], v[20:23], v[208:223]
    buffer_load_dwordx4 v[60:63], v13, s[16:19], s68 offen offset:2048 sc1
    v_mfma_f32_32x32x16_bf16 v[224:239], v[164:167], v[16:19], v[224:239]
    v_mfma_f32_32x32x16_bf16 v[240:255], v[164:167], v[20:23], v[240:255]
    s_waitcnt vmcnt(17)
    v_mfma_f32_32x32x16_bf16 v[192:207], v[168:171], v[24:27], v[192:207]
    ds_read_b64_tr_b16 v[144:145], v14 offset:0
    ds_read_b64_tr_b16 v[146:147], v14 offset:512
    s_add_u32 s68, s79, 36864
    buffer_load_dwordx4 v[16:19], v9, s[16:19], s68 offen offset:0 sc1
    s_waitcnt vmcnt(16)
    v_mfma_f32_32x32x16_bf16 v[208:223], v[168:171], v[28:31], v[208:223]
    ds_read_b64_tr_b16 v[148:149], v15 offset:0
    ds_read_b64_tr_b16 v[150:151], v15 offset:512
    buffer_load_dwordx4 v[20:23], v13, s[16:19], s68 offen offset:0 sc1
    v_mfma_f32_32x32x16_bf16 v[224:239], v[172:175], v[24:27], v[224:239]
    ds_read_b64_tr_b16 v[152:153], v14 offset:1024
    ds_read_b64_tr_b16 v[154:155], v14 offset:1536
    v_mfma_f32_32x32x16_bf16 v[240:255], v[172:175], v[28:31], v[240:255]
    ds_read_b64_tr_b16 v[156:157], v15 offset:1024
    ds_read_b64_tr_b16 v[158:159], v15 offset:1536
    s_waitcnt vmcnt(13)
    v_mfma_f32_32x32x16_bf16 v[192:207], v[176:179], v[32:35], v[192:207]
    buffer_load_dwordx4 v[24:27], v9, s[16:19], s68 offen offset:2048 sc1
    s_waitcnt lgkmcnt(0)
    s_waitcnt vmcnt(13)
    v_mfma_f32_32x32x16_bf16 v[208:223], v[176:179], v[36:39], v[208:223]
    buffer_load_dwordx4 v[28:31], v13, s[16:19], s68 offen offset:2048 sc1
    v_mfma_f32_32x32x16_bf16 v[224:239], v[180:183], v[32:35], v[224:239]
    v_mfma_f32_32x32x16_bf16 v[240:255], v[180:183], v[36:39], v[240:255]
    s_waitcnt vmcnt(13)
    v_mfma_f32_32x32x16_bf16 v[192:207], v[184:187], v[40:43], v[192:207]
    ds_read_b64_tr_b16 v[160:161], v14 offset:4096
    ds_read_b64_tr_b16 v[162:163], v14 offset:4608
    s_add_u32 s68, s79, 40960
    buffer_load_dwordx4 v[32:35], v9, s[16:19], s68 offen offset:0 sc1
    s_waitcnt vmcnt(12)
    v_mfma_f32_32x32x16_bf16 v[208:223], v[184:187], v[44:47], v[208:223]
    ds_read_b64_tr_b16 v[164:165], v15 offset:4096
    ds_read_b64_tr_b16 v[166:167], v15 offset:4608
    buffer_load_dwordx4 v[36:39], v13, s[16:19], s68 offen offset:0 sc1
    v_mfma_f32_32x32x16_bf16 v[224:239], v[188:191], v[40:43], v[224:239]
    ds_read_b64_tr_b16 v[168:169], v14 offset:5120
    ds_read_b64_tr_b16 v[170:171], v14 offset:5632
    v_mfma_f32_32x32x16_bf16 v[240:255], v[188:191], v[44:47], v[240:255]
    ds_read_b64_tr_b16 v[172:173], v15 offset:5120
    ds_read_b64_tr_b16 v[174:175], v15 offset:5632
    s_waitcnt vmcnt(9)
    v_mfma_f32_32x32x16_bf16 v[192:207], v[64:67], v[48:51], v[192:207]
    buffer_load_dwordx4 v[40:43], v9, s[16:19], s68 offen offset:2048 sc1
    s_waitcnt lgkmcnt(0)
    s_waitcnt vmcnt(9)
    v_mfma_f32_32x32x16_bf16 v[208:223], v[64:67], v[52:55], v[208:223]
    buffer_load_dwordx4 v[44:47], v13, s[16:19], s68 offen offset:2048 sc1
    v_mfma_f32_32x32x16_bf16 v[224:239], v[68:71], v[48:51], v[224:239]
    v_mfma_f32_32x32x16_bf16 v[240:255], v[68:71], v[52:55], v[240:255]
    s_waitcnt vmcnt(9)
    v_mfma_f32_32x32x16_bf16 v[192:207], v[72:75], v[56:59], v[192:207]
    ds_read_b64_tr_b16 v[176:177], v14 offset:8192
    ds_read_b64_tr_b16 v[178:179], v14 offset:8704
    s_add_u32 s68, s79, 45056
    buffer_load_dwordx4 v[48:51], v9, s[16:19], s68 offen offset:0 sc1
    s_waitcnt vmcnt(9)
    v_mfma_f32_32x32x16_bf16 v[208:223], v[72:75], v[60:63], v[208:223]
    ds_read_b64_tr_b16 v[180:181], v15 offset:8192
    ds_read_b64_tr_b16 v[182:183], v15 offset:8704
    buffer_load_dwordx4 v[52:55], v13, s[16:19], s68 offen offset:0 sc1
    v_mfma_f32_32x32x16_bf16 v[224:239], v[76:79], v[56:59], v[224:239]
    ds_read_b64_tr_b16 v[184:185], v14 offset:9216
    ds_read_b64_tr_b16 v[186:187], v14 offset:9728
    v_mfma_f32_32x32x16_bf16 v[240:255], v[76:79], v[60:63], v[240:255]
    ds_read_b64_tr_b16 v[188:189], v15 offset:9216
    ds_read_b64_tr_b16 v[190:191], v15 offset:9728
    s_waitcnt vmcnt(9)
    v_mfma_f32_32x32x16_bf16 v[192:207], v[80:83], v[16:19], v[192:207]
    buffer_load_dwordx4 v[56:59], v9, s[16:19], s68 offen offset:2048 sc1
    s_waitcnt lgkmcnt(0)
    s_waitcnt vmcnt(9)
    v_mfma_f32_32x32x16_bf16 v[208:223], v[80:83], v[20:23], v[208:223]
    buffer_load_dwordx4 v[60:63], v13, s[16:19], s68 offen offset:2048 sc1
    v_mfma_f32_32x32x16_bf16 v[224:239], v[84:87], v[16:19], v[224:239]
    v_mfma_f32_32x32x16_bf16 v[240:255], v[84:87], v[20:23], v[240:255]
    s_waitcnt vmcnt(9)
    v_mfma_f32_32x32x16_bf16 v[192:207], v[88:91], v[24:27], v[192:207]
    ds_read_b64_tr_b16 v[64:65], v14 offset:53248
    ds_read_b64_tr_b16 v[66:67], v14 offset:53760
    s_add_u32 s68, s79, 49152
    buffer_load_dwordx4 v[16:19], v9, s[16:19], s68 offen offset:0 sc1
    s_waitcnt vmcnt(9)
    v_mfma_f32_32x32x16_bf16 v[208:223], v[88:91], v[28:31], v[208:223]
    ds_read_b64_tr_b16 v[68:69], v15 offset:53248
    ds_read_b64_tr_b16 v[70:71], v15 offset:53760
    buffer_load_dwordx4 v[20:23], v13, s[16:19], s68 offen offset:0 sc1
    v_mfma_f32_32x32x16_bf16 v[224:239], v[92:95], v[24:27], v[224:239]
    ds_read_b64_tr_b16 v[72:73], v14 offset:54272
    ds_read_b64_tr_b16 v[74:75], v14 offset:54784
    v_mfma_f32_32x32x16_bf16 v[240:255], v[92:95], v[28:31], v[240:255]
    ds_read_b64_tr_b16 v[76:77], v15 offset:54272
    ds_read_b64_tr_b16 v[78:79], v15 offset:54784
    s_andn2_b32 s3, 0xf, s69
    s_cbranch_scc0 P2p14
    v_mov_b32 v10, 0
    v_mov_b32 v11, 0
    s_mov_b64 exec, 0xffff
    buffer_atomic_or_x2 v[10:11], v8, s[16:19], s76 offen sc0 sc1
    s_mov_b64 exec, -1
P2p14:
    s_waitcnt vmcnt(9)
    v_mfma_f32_32x32x16_bf16 v[192:207], v[96:99], v[32:35], v[192:207]
    buffer_load_dwordx4 v[24:27], v9, s[16:19], s68 offen offset:2048 sc1
    s_waitcnt lgkmcnt(0)
    s_waitcnt vmcnt(9)
    v_mfma_f32_32x32x16_bf16 v[208:223], v[96:99], v[36:39], v[208:223]
    buffer_load_dwordx4 v[28:31], v13, s[16:19], s68 offen offset:2048 sc1
    v_mfma_f32_32x32x16_bf16 v[224:239], v[100:103], v[32:35], v[224:239]
    v_mfma_f32_32x32x16_bf16 v[240:255], v[100:103], v[36:39], v[240:255]
    s_waitcnt vmcnt(9)
    v_mfma_f32_32x32x16_bf16 v[192:207], v[104:107], v[40:43], v[192:207]
    ds_read_b64_tr_b16 v[80:81], v14 offset:57344
    ds_read_b64_tr_b16 v[82:83], v14 offset:57856
    s_add_u32 s68, s79, 53248
    buffer_load_dwordx4 v[32:35], v9, s[16:19], s68 offen offset:0 sc1
    s_waitcnt vmcnt(9)
    v_mfma_f32_32x32x16_bf16 v[208:223], v[104:107], v[44:47], v[208:223]
    ds_read_b64_tr_b16 v[84:85], v15 offset:57344
    ds_read_b64_tr_b16 v[86:87], v15 offset:57856
    buffer_load_dwordx4 v[36:39], v13, s[16:19], s68 offen offset:0 sc1
    v_mfma_f32_32x32x16_bf16 v[224:239], v[108:111], v[40:43], v[224:239]
    ds_read_b64_tr_b16 v[88:89], v14 offset:58368
    ds_read_b64_tr_b16 v[90:91], v14 offset:58880
    v_mfma_f32_32x32x16_bf16 v[240:255], v[108:111], v[44:47], v[240:255]
    ds_read_b64_tr_b16 v[92:93], v15 offset:58368
    ds_read_b64_tr_b16 v[94:95], v15 offset:58880
    s_waitcnt vmcnt(9)
    v_mfma_f32_32x32x16_bf16 v[192:207], v[112:115], v[48:51], v[192:207]
    buffer_load_dwordx4 v[40:43], v9, s[16:19], s68 offen offset:2048 sc1
    s_waitcnt lgkmcnt(0)
    s_waitcnt vmcnt(9)
    v_mfma_f32_32x32x16_bf16 v[208:223], v[112:115], v[52:55], v[208:223]
    buffer_load_dwordx4 v[44:47], v13, s[16:19], s68 offen offset:2048 sc1
    v_mfma_f32_32x32x16_bf16 v[224:239], v[116:119], v[48:51], v[224:239]
    v_mfma_f32_32x32x16_bf16 v[240:255], v[116:119], v[52:55], v[240:255]
    s_waitcnt vmcnt(9)
    v_mfma_f32_32x32x16_bf16 v[192:207], v[120:123], v[56:59], v[192:207]
    s_andn2_b32 s3, 0xf, s69
    s_cbranch_scc0 P2k14
    s_waitcnt vmcnt(6)
    s_mov_b32 s7, 0
P2c14:
    v_cmp_eq_u32 vcc, s88, v10
    v_cmp_eq_u32 s[4:5], s89, v11
    s_nop 0
    s_and_b32 s69, vcc_lo, s4
    s_andn2_b32 s3, 0xf, s69
    s_cbranch_scc0 P2k14
    s_add_u32 s7, s7, 1
    s_cmp_ge_u32 s7, 20000
    s_cbranch_scc1 P2k14
    s_sleep 1
    s_nop 7
    v_mov_b32 v10, 0
    v_mov_b32 v11, 0
    s_mov_b64 exec, 0xffff
    buffer_atomic_or_x2 v[10:11], v8, s[16:19], s76 offen sc0 sc1
    s_mov_b64 exec, -1
    s_waitcnt vmcnt(0)
    s_branch P2c14
P2k14:
    s_add_u32 s68, s79, 57344
    buffer_load_dwordx4 v[48:51], v9, s[16:19], s68 offen offset:0 sc1
    s_waitcnt vmcnt(9)
    v_mfma_f32_32x32x16_bf16 v[208:223], v[120:123], v[60:63], v[208:223]
    buffer_load_dwordx4 v[52:55], v13, s[16:19], s68 offen offset:0 sc1
    v_mfma_f32_32x32x16_bf16 v[224:239], v[124:127], v[56:59], v[224:239]
    v_mfma_f32_32x32x16_bf16 v[240:255], v[124:127], v[60:63], v[240:255]
    s_waitcnt vmcnt(9)
    v_mfma_f32_32x32x16_bf16 v[192:207], v[128:131], v[16:19], v[192:207]
    buffer_load_dwordx4 v[56:59], v9, s[16:19], s68 offen offset:2048 sc1
    s_waitcnt vmcnt(9)
    v_mfma_f32_32x32x16_bf16 v[208:223], v[128:131], v[20:23], v[208:223]
    buffer_load_dwordx4 v[60:63], v13, s[16:19], s68 offen offset:2048 sc1
    v_mfma_f32_32x32x16_bf16 v[224:239], v[132:135], v[16:19], v[224:239]
    v_mfma_f32_32x32x16_bf16 v[240:255], v[132:135], v[20:23], v[240:255]
    s_waitcnt vmcnt(9)
    v_mfma_f32_32x32x16_bf16 v[192:207], v[136:139], v[24:27], v[192:207]
    s_add_u32 s68, s79, 61440
    buffer_load_dwordx4 v[16:19], v9, s[16:19], s68 offen offset:0 sc1
    s_waitcnt vmcnt(9)
    v_mfma_f32_32x32x16_bf16 v[208:223], v[136:139], v[28:31], v[208:223]
    buffer_load_dwordx4 v[20:23], v13, s[16:19], s68 offen offset:0 sc1
    v_mfma_f32_32x32x16_bf16 v[224:239], v[140:143], v[24:27], v[224:239]
    v_mfma_f32_32x32x16_bf16 v[240:255], v[140:143], v[28:31], v[240:255]
    s_waitcnt vmcnt(9)
    v_mfma_f32_32x32x16_bf16 v[192:207], v[144:147], v[32:35], v[192:207]
    buffer_load_dwordx4 v[24:27], v9, s[16:19], s68 offen offset:2048 sc1
    s_waitcnt vmcnt(9)
    v_mfma_f32_32x32x16_bf16 v[208:223], v[144:147], v[36:39], v[208:223]
    buffer_load_dwordx4 v[28:31], v13, s[16:19], s68 offen offset:2048 sc1
    v_mfma_f32_32x32x16_bf16 v[224:239], v[148:151], v[32:35], v[224:239]
    v_mfma_f32_32x32x16_bf16 v[240:255], v[148:151], v[36:39], v[240:255]
    s_waitcnt vmcnt(9)
    v_mfma_f32_32x32x16_bf16 v[192:207], v[152:155], v[40:43], v[192:207]
    s_add_u32 s68, s79, 65536
    buffer_load_dwordx4 v[32:35], v9, s[16:19], s68 offen offset:0 sc1
    s_waitcnt vmcnt(9)
    v_mfma_f32_32x32x16_bf16 v[208:223], v[152:155], v[44:47], v[208:223]
    buffer_load_dwordx4 v[36:39], v13, s[16:19], s68 offen offset:0 sc1
    v_mfma_f32_32x32x16_bf16 v[224:239], v[156:159], v[40:43], v[224:239]
    v_mfma_f32_32x32x16_bf16 v[240:255], v[156:159], v[44:47], v[240:255]
    s_waitcnt vmcnt(9)
    v_mfma_f32_32x32x16_bf16 v[192:207], v[160:163], v[48:51], v[192:207]
    buffer_load_dwordx4 v[40:43], v9, s[16:19], s68 offen offset:2048 sc1
    s_waitcnt vmcnt(9)
    v_mfma_f32_32x32x16_bf16 v[208:223], v[160:163], v[52:55], v[208:223]
    buffer_load_dwordx4 v[44:47], v13, s[16:19], s68 offen offset:2048 sc1
    v_mfma_f32_32x32x16_bf16 v[224:239], v[164:167], v[48:51], v[224:239]
    v_mfma_f32_32x32x16_bf16 v[240:255], v[164:167], v[52:55], v[240:255]
    s_waitcnt vmcnt(9)
    v_mfma_f32_32x32x16_bf16 v[192:207], v[168:171], v[56:59], v[192:207]
    s_add_u32 s68, s79, 69632
    buffer_load_dwordx4 v[48:51], v9, s[16:19], s68 offen offset:0 sc1
    s_waitcnt vmcnt(9)
    v_mfma_f32_32x32x16_bf16 v[208:223], v[168:171], v[60:63], v[208:223]
    buffer_load_dwordx4 v[52:55], v13, s[16:19], s68 offen offset:0 sc1
    v_mfma_f32_32x32x16_bf16 v[224:239], v[172:175], v[56:59], v[224:239]
    v_mfma_f32_32x32x16_bf16 v[240:255], v[172:175], v[60:63], v[240:255]
    s_waitcnt vmcnt(9)
    v_mfma_f32_32x32x16_bf16 v[192:207], v[176:179], v[16:19], v[192:207]
    buffer_load_dwordx4 v[56:59], v9, s[16:19], s68 offen offset:2048 sc1
    s_waitcnt vmcnt(9)
    v_mfma_f32_32x32x16_bf16 v[208:223], v[176:179], v[20:23], v[208:223]
    buffer_load_dwordx4 v[60:63], v13, s[16:19], s68 offen offset:2048 sc1
    v_mfma_f32_32x32x16_bf16 v[224:239], v[180:183], v[16:19], v[224:239]
    v_mfma_f32_32x32x16_bf16 v[240:255], v[180:183], v[20:23], v[240:255]
    s_waitcnt vmcnt(9)
    v_mfma_f32_32x32x16_bf16 v[192:207], v[184:187], v[24:27], v[192:207]
    s_waitcnt vmcnt(8)
    v_mfma_f32_32x32x16_bf16 v[208:223], v[184:187], v[28:31], v[208:223]
    v_mfma_f32_32x32x16_bf16 v[224:239], v[188:191], v[24:27], v[224:239]
    v_mfma_f32_32x32x16_bf16 v[240:255], v[188:191], v[28:31], v[240:255]
    v_lshrrev_b32 v2, 5, v1
    v_lshlrev_b32 v2, 7, v2
    v_xor_b32 v2, v2, v6
    v_add_u32 v2, s82, v2
    v_xor_b32 v3, 64, v2
    s_waitcnt vmcnt(7)
    v_mfma_f32_32x32x16_bf16 v[192:207], v[64:67], v[32:35], v[192:207]
    s_waitcnt vmcnt(6)
    v_mfma_f32_32x32x16_bf16 v[208:223], v[64:67], v[36:39], v[208:223]
    v_mfma_f32_32x32x16_bf16 v[224:239], v[68:71], v[32:35], v[224:239]
    v_mfma_f32_32x32x16_bf16 v[240:255], v[68:71], v[36:39], v[240:255]
    s_waitcnt vmcnt(5)
    v_mfma_f32_32x32x16_bf16 v[192:207], v[72:75], v[40:43], v[192:207]
    s_waitcnt vmcnt(4)
    v_mfma_f32_32x32x16_bf16 v[208:223], v[72:75], v[44:47], v[208:223]
    v_mfma_f32_32x32x16_bf16 v[224:239], v[76:79], v[40:43], v[224:239]
    v_mfma_f32_32x32x16_bf16 v[240:255], v[76:79], v[44:47], v[240:255]
    s_waitcnt vmcnt(3)
    v_mfma_f32_32x32x16_bf16 v[192:207], v[80:83], v[48:51], v[192:207]
    s_waitcnt vmcnt(1)
    v_mfma_f32_32x32x16_bf16 v[192:207], v[88:91], v[56:59], v[192:207]
    v_mfma_f32_32x32x16_bf16 v[208:223], v[80:83], v[52:55], v[208:223]
    s_waitcnt vmcnt(0)
    v_mfma_f32_32x32x16_bf16 v[208:223], v[88:91], v[60:63], v[208:223]
    v_mfma_f32_32x32x16_bf16 v[224:239], v[84:87], v[48:51], v[224:239]
    v_mfma_f32_32x32x16_bf16 v[224:239], v[92:95], v[56:59], v[224:239]
    s_nop 6
    ds_write_b128 v2, v[192:195] offset:0
    ds_write_b128 v2, v[196:199] offset:1024
    ds_write_b128 v3, v[200:203] offset:2048
    ds_write_b128 v3, v[204:207] offset:3072
    v_mfma_f32_32x32x16_bf16 v[240:255], v[84:87], v[52:55], v[240:255]
    v_mfma_f32_32x32x16_bf16 v[240:255], v[92:95], v[60:63], v[240:255]
    ds_write_b128 v2, v[208:211] offset:4096
    ds_write_b128 v2, v[212:215] offset:5120
    ds_write_b128 v3, v[216:219] offset:6144
    ds_write_b128 v3, v[220:223] offset:7168
    ds_write_b128 v2, v[224:227] offset:8192
    ds_write_b128 v2, v[228:231] offset:9216
    ds_write_b128 v3, v[232:235] offset:10240
    ds_write_b128 v3, v[236:239] offset:11264
    s_nop 3
    ds_write_b128 v2, v[240:243] offset:49152
    ds_write_b128 v2, v[244:247] offset:50176
    ds_write_b128 v3, v[248:251] offset:51200
    ds_write_b128 v3, v[252:255] offset:52224
    s_branch L_fin
L_finA:
    s_and_b32 s77, s2, 7
    s_lshl_b32 s77, s77, 2
    s_bfe_u32 s3, s2, 0x20003
    s_add_u32 s77, s77, s3
    s_lshr_b32 s78, s2, 5
L_fin:
    v_lshrrev_b32 v13, 3, v1
    v_and_b32 v14, 7, v1
    s_lshl_b32 s67, s77, 6
    s_lshl_b32 s68, s54, 3
    s_add_u32 s67, s67, s68
    s_lshl_b32 s67, s67, 10
    s_lshl_b32 s69, s78, 7
    s_add_u32 s67, s67, s69
    v_lshlrev_b32 v12, 4, v14
    v_lshl_or_b32 v12, v13, 10, v12
    s_and_b32 s68, s68, 31
    v_add_u32 v13, s68, v13
    v_and_b32 v15, 3, v14
    v_lshlrev_b32 v4, 2, v15
    v_xor_b32 v13, v13, v4
    v_lshlrev_b32 v13, 4, v13
    v_lshrrev_b32 v4, 1, v15
    v_lshl_or_b32 v13, v4, 9, v13
    v_and_b32 v4, 1, v15
    v_lshl_or_b32 v13, v4, 11, v13
    v_lshrrev_b32 v14, 2, v14
    s_lshr_b32 s68, s54, 2
    v_lshl_or_b32 v14, v14, 1, s68
    v_mov_b32 v15, 49152
    v_xor_b32 v4, 0, v14
    v_cmp_eq_u32 vcc, 3, v4
    v_lshlrev_b32 v4, 12, v4
    v_add_u32 v5, 40960, v13
    v_cndmask_b32 v4, v4, v15, vcc
    v_add_u32 v8, v4, v5
    v_xor_b32 v4, 1, v14
    v_cmp_eq_u32 vcc, 3, v4
    v_lshlrev_b32 v4, 12, v4
    v_add_u32 v5, 53248, v13
    v_cndmask_b32 v4, v4, v15, vcc
    v_add_u32 v9, v4, v5
    v_xor_b32 v4, 2, v14
    v_cmp_eq_u32 vcc, 3, v4
    v_lshlrev_b32 v4, 12, v4
    v_add_u32 v5, 65536, v13
    v_cndmask_b32 v4, v4, v15, vcc
    v_add_u32 v10, v4, v5
    v_xor_b32 v4, 3, v14
    v_cmp_eq_u32 vcc, 3, v4
    v_lshlrev_b32 v4, 12, v4
    v_add_u32 v5, 77824, v13
    v_cndmask_b32 v4, v4, v15, vcc
    v_add_u32 v11, v4, v5
    s_lshl_b32 s68, s55, 10
    s_add_u32 s68, s68, 155648
    v_add_u32 v5, s68, v6
    s_cmp_ge_u32 s54, 4
    s_cbranch_scc1 L_fb
    s_add_u32 s68, s67, 0x8000
    buffer_load_dwordx4 v[100:103], v12, s[8:11], s68 offen
    buffer_load_dwordx4 v[96:99], v12, s[8:11], s67 offen
    s_mov_b32 s7, 0
L_ff:
    ds_read_b32 v16, v2 offset:32544
    s_waitcnt lgkmcnt(0)
    v_readfirstlane_b32 s3, v16
    s_nop 0
    s_cmp_ge_u32 s3, 4
    s_cbranch_scc1 L_ffk
    s_add_u32 s7, s7, 1
    s_cmp_ge_u32 s7, 0x200000
    s_cbranch_scc1 L_ffk
    s_sleep 1
    s_nop 7
    s_branch L_ff
L_ffk:
    s_waitcnt vmcnt(1)
    ds_write_b128 v5, v[100:103]
    s_waitcnt vmcnt(0) lgkmcnt(0)
    s_barrier
    s_branch L_fc
L_fb:
    s_waitcnt lgkmcnt(0)
    s_barrier
    ds_read_b128 v[96:99], v5
L_fc:
    ds_read_b128 v[64:67], v8 offset:0
    ds_read_b128 v[68:71], v8 offset:1024
    ds_read_b128 v[72:75], v9 offset:0
    ds_read_b128 v[76:79], v9 offset:1024
    ds_read_b128 v[80:83], v10 offset:0
    ds_read_b128 v[84:87], v10 offset:1024
    ds_read_b128 v[88:91], v11 offset:0
    ds_read_b128 v[92:95], v11 offset:1024
    s_waitcnt lgkmcnt(6)
    v_lshlrev_b32 v104, 16, v96
    v_and_b32 v105, 0xffff0000, v96
    v_lshlrev_b32 v106, 16, v97
    v_and_b32 v107, 0xffff0000, v97
    v_lshlrev_b32 v108, 16, v98
    v_and_b32 v109, 0xffff0000, v98
    v_lshlrev_b32 v110, 16, v99
    v_and_b32 v111, 0xffff0000, v99
    v_pk_add_f32 v[64:65], v[64:65], v[104:105]
    v_pk_add_f32 v[66:67], v[66:67], v[106:107]
    v_pk_add_f32 v[68:69], v[68:69], v[108:109]
    v_pk_add_f32 v[70:71], v[70:71], v[110:111]
    s_waitcnt lgkmcnt(4)
    v_pk_add_f32 v[64:65], v[64:65], v[72:73]
    v_pk_add_f32 v[66:67], v[66:67], v[74:75]
    v_pk_add_f32 v[68:69], v[68:69], v[76:77]
    v_pk_add_f32 v[70:71], v[70:71], v[78:79]
    s_waitcnt lgkmcnt(0)
    v_pk_add_f32 v[80:81], v[80:81], v[88:89]
    v_pk_add_f32 v[82:83], v[82:83], v[90:91]
    v_pk_add_f32 v[84:85], v[84:85], v[92:93]
    v_pk_add_f32 v[86:87], v[86:87], v[94:95]
    v_pk_add_f32 v[64:65], v[64:65], v[80:81]
    v_pk_add_f32 v[66:67], v[66:67], v[82:83]
    v_pk_add_f32 v[68:69], v[68:69], v[84:85]
    v_pk_add_f32 v[70:71], v[70:71], v[86:87]
    v_cvt_pk_bf16_f32 v72, v64, v65
    v_cvt_pk_bf16_f32 v73, v66, v67
    v_cvt_pk_bf16_f32 v74, v68, v69
    v_cvt_pk_bf16_f32 v75, v70, v71
    buffer_store_dwordx4 v[72:75], v12, s[28:31], s67 offen sc1
    s_endpgm
L_done:
    s_endpgm
L_codeend:
.section .rodata,"a"
.p2align 6
.amdhsa_kernel parallel_sum__sliding_local_dilated__dense_activation_silu__prompt_kernel
  .amdhsa_next_free_vgpr 256
  .amdhsa_next_free_sgpr 102
  .amdhsa_accum_offset 256
  .amdhsa_group_segment_fixed_size 0
  .amdhsa_kernarg_size 72
  .amdhsa_user_sgpr_count 2
  .amdhsa_user_sgpr_kernarg_segment_ptr 1
  .amdhsa_system_sgpr_workgroup_id_x 1
.end_amdhsa_kernel
```
